```python
import torch

def _softmax(x, axis=-1):
    return torch.softmax(x, dim=axis)
def _gelu(x):
    return torch.nn.functional.gelu(x, approximate="tanh")
def _silu(x):
    return torch.nn.functional.silu(x)
def _sigmoid(x):
    return torch.sigmoid(x)
def _layernorm(x, axis=-1, eps=1e-5):
    m = x.mean(dim=axis, keepdim=True)
    v = x.var(dim=axis, keepdim=True, unbiased=False)
    return (x - m) / torch.sqrt(v + eps)
def _scatter_add(tgt, idx, src, axis=0):
    return tgt.clone().index_add_(axis, idx, src)
def _segment_sum(src, seg, n):
    out = torch.zeros((n,) + src.shape[1:], dtype=src.dtype)
    return out.index_add_(0, seg, src)
def _pad(x, pw):
    flat = tuple(v for pair in reversed(pw) for v in pair)
    return torch.nn.functional.pad(x, flat)

kernel_name = 'concat_heads__gqa_block_cached__sliding_block_cached__decode'

def setup_inputs():

    _w = (lambda a: (lambda t: t.to(torch.bfloat16) if t.is_floating_point() else t)(torch.as_tensor(a)))
    def _A_setup():
        B, Sq, D = 4, 1, 512
        Hq, Hkv, Sk, Dh = 32, 8, 8192, 128
        assert Hq % Hkv == 0, (Hq, Hkv)
        return {
            "x": _w((lambda *s: torch.randn(*s, dtype=torch.bfloat16) * 0.8)(B, Sq, D)),
            "k_cache": _w((lambda *s: torch.randn(*s, dtype=torch.bfloat16) * 1.6)(B, Hkv, Sk, Dh)),
            "v_cache": _w((lambda *s: torch.randn(*s, dtype=torch.bfloat16) * 0.2)(B, Hkv, Sk, Dh)),
            "wq": _w((lambda *s: torch.randn(*s, dtype=torch.bfloat16) * 1.6)(D, Hq * Dh) * (D ** -0.5)),
            "wo": _w((lambda *s: torch.randn(*s, dtype=torch.bfloat16) * 0.2)(Hq * Dh, D) * ((Hq * Dh) ** -0.5)),
        }
    _A_in = _A_setup()

    def _B_setup():
        B, Sq, D = 4, 1, 512
        Hq, Hkv, Sk, Dh = 32, 8, 8192, 128
        assert Hq % Hkv == 0, (Hq, Hkv)
        return {
            "x": _w((lambda *s: torch.randn(*s, dtype=torch.bfloat16) * 0.8)(B, Sq, D)),
            "k_cache": _w((lambda *s: torch.randn(*s, dtype=torch.bfloat16) * 1.6)(B, Hkv, Sk, Dh)),
            "v_cache": _w((lambda *s: torch.randn(*s, dtype=torch.bfloat16) * 0.2)(B, Hkv, Sk, Dh)),
            "wq": _w((lambda *s: torch.randn(*s, dtype=torch.bfloat16) * 1.6)(D, Hq * Dh) * (D ** -0.5)),
            "wo": _w((lambda *s: torch.randn(*s, dtype=torch.bfloat16) * 0.2)(Hq * Dh, D) * ((Hq * Dh) ** -0.5)),
        }
    _B_in = _B_setup()

    return {
        "A_x": _A_in["x"],
        "A_k_cache": _A_in["k_cache"],
        "A_v_cache": _A_in["v_cache"],
        "A_wq": _A_in["wq"],
        "A_wo": _A_in["wo"],
        "B_x": _B_in["x"],
        "B_k_cache": _B_in["k_cache"],
        "B_v_cache": _B_in["v_cache"],
        "B_wq": _B_in["wq"],
        "B_wo": _B_in["wo"],
    }

def reference(A_x, A_k_cache, A_v_cache, A_wq, A_wo, B_x, B_k_cache, B_v_cache, B_wq, B_wo):
    def _A_ref(x, k_cache, v_cache, wq, wo):
        B, Sq, D = x.shape
        Hq, Dh = 32, 128
        Hkv = k_cache.shape[1]
        rep = Hq // Hkv
        q = (lambda x, *d: x.permute(*d))((x @ wq).reshape(B, Sq, Hq, Dh), 0, 2, 1, 3)
        k = (lambda x, n, axis: torch.repeat_interleave(x, n, dim=axis))(k_cache, rep, axis=1)
        v = (lambda x, n, axis: torch.repeat_interleave(x, n, dim=axis))(v_cache, rep, axis=1)
        scores = torch.einsum("bhqd,bhkd->bhqk", q, k) * (Dh ** -0.5)
        p = _softmax(scores, axis=-1)
        o = torch.einsum("bhqk,bhkd->bhqd", p, v)
        return (lambda x, *d: x.permute(*d))(o, 0, 2, 1, 3).reshape(B, Sq, Hq * Dh) @ wo

    def _B_ref(x, k_cache, v_cache, wq, wo):
        B, Sq, D = x.shape
        Hq, Dh = 32, 128
        Hkv, Sk = k_cache.shape[1], k_cache.shape[2]
        W = min(4096, max(256, Sk // 4))
        rep = Hq // Hkv
        q = (lambda x, *d: x.permute(*d))((x @ wq).reshape(B, Sq, Hq, Dh), 0, 2, 1, 3)
        k = (lambda x, n, axis: torch.repeat_interleave(x, n, dim=axis))(k_cache[:, :, Sk - W:, :], rep, axis=1)
        v = (lambda x, n, axis: torch.repeat_interleave(x, n, dim=axis))(v_cache[:, :, Sk - W:, :], rep, axis=1)
        scores = torch.einsum("bhqd,bhkd->bhqk", q, k) * (Dh ** -0.5)
        p = _softmax(scores, axis=-1)
        o = torch.einsum("bhqk,bhkd->bhqd", p, v)
        return (lambda x, *d: x.permute(*d))(o, 0, 2, 1, 3).reshape(B, Sq, Hq * Dh) @ wo

    a = _A_ref(A_x, A_k_cache, A_v_cache, A_wq, A_wo)
    b = _B_ref(B_x, B_k_cache, B_v_cache, B_wq, B_wo)
    return torch.concatenate([a, b], axis=-1)
```

```asm
; @launch grid=(256,1,1) block=(256,1,1) lds=160768
.amdgcn_target "amdgcn-amd-amdhsa--gfx950"
.text
.globl concat_heads__gqa_block_cached__sliding_block_cached__decode_kernel
.p2align 8
.type concat_heads__gqa_block_cached__sliding_block_cached__decode_kernel,@function
concat_heads__gqa_block_cached__sliding_block_cached__decode_kernel:
    s_cmp_ge_u32 s2, 256
    s_cbranch_scc1 L_end
    s_lshr_b32 s7, s2, 7
    s_mul_i32 s6, s7, 40
    s_load_dwordx2 s[24:25], s[0:1], s6 offset:24
    s_getpc_b64 s[4:5]
L_pc:
    s_lshr_b32 s6, s2, 3
    s_lshl_b32 s6, s6, 9
    v_lshl_add_u32 v88, v0, 1, s6
    v_min_u32 v88, L_code_end-L_pc-4, v88
    v_and_b32 v88, -4, v88
    v_mov_b32 v89, s5
    v_add_co_u32 v88, vcc, s4, v88
    s_nop 1
    v_addc_co_u32 v89, vcc, 0, v89, vcc
    global_load_dword v191, v[88:89], off
    v_lshrrev_b32 v3, 6, v0
    v_lshlrev_b32 v7, 19, v3
    v_readfirstlane_b32 s48, v3
    v_and_b32 v4, 56, v0
    v_lshl_add_u32 v7, v4, 10, v7
    v_lshrrev_b32 v4, 3, v0
    v_and_b32 v4, 2, v4
    v_xor_b32 v4, v4, v0
    v_and_b32 v4, 7, v4
    v_lshl_add_u32 v7, v4, 4, v7
    s_and_b32 s5, s2, 63
    s_lshr_b32 s6, s5, 3
    s_xor_b32 s59, s5, s6
    s_lshl_b32 s59, s59, 7
    s_and_b32 s6, s2, 64
    s_lshl_b32 s5, s6, 15
    s_add_u32 s5, s5, s59
    s_lshl_b32 s6, 1, 16
    s_lshl_b32 s26, 1, 22
    s_mov_b32 s27, 0x20000
    s_lshl_b32 s57, s48, 15
    s_addk_i32 s57, 29696
    s_mov_b32 m0, s57
    s_mov_b32 s56, 7
    s_waitcnt lgkmcnt(0)
L_wq:
    buffer_load_dwordx4 v7, s[24:27], s5 offen nt lds
    s_add_u32 s5, s5, s6
    s_addk_i32 m0, 1088
    s_sub_u32 s56, s56, 1
    s_cbranch_scc0 L_wq
    s_mul_i32 s6, s7, 40
    s_load_dwordx2 s[32:33], s[0:1], s6
    s_load_dwordx16 s[68:83], s[0:1], 0
    s_load_dwordx8 s[84:91], s[0:1], 64
    s_load_dwordx2 s[92:93], s[0:1], 96
    v_and_b32 v0, 63, v0
    v_and_b32 v123, 48, v0
    v_lshlrev_b32 v2, 4, v0
    v_and_b32 v124, 0xf0, v2
    v_lshl_add_u32 v5, v123, 6, v124
    s_movk_i32 s34, 4096
    s_mov_b32 s35, 0x20000
    s_lshr_b32 s6, s2, 4
    s_and_b32 s6, s6, 4
    s_add_u32 s5, s6, s48
    s_lshl_b32 s53, s5, 7
    s_waitcnt lgkmcnt(0)
    buffer_load_dwordx4 v5, s[32:35], s53 offen lds
    s_lshl_b32 s6, s6, 11
    s_add_u32 s59, s59, s6
    s_lshl_b32 s6, s7, 14
    s_add_u32 s59, s59, s6
    v_and_b32 v3, 3, v0
    v_bfe_u32 v6, v0, 2, 2
    s_and_b32 s49, s2, 7
    s_lshr_b32 s50, s2, 3
    s_lshr_b32 s98, s2, 4
    s_lshl_b32 s98, s98, 1
    s_bfe_u32 s3, s2, 65537
    s_add_u32 s98, s98, s3
    s_and_b32 s3, s2, 5
    s_lshr_b32 s4, s3, 1
    s_or_b32 s3, s3, s4
    s_and_b32 s3, s3, 3
    s_and_b32 s5, s50, 1
    s_mul_i32 s99, s3, 2
    s_add_u32 s99, s99, s5
    s_lshl_b32 s5, s5, 14
    s_mul_i32 s66, s3, 32768
    s_add_u32 s66, s66, s5
    s_mul_i32 s4, s3, 32768
    s_add_u32 s4, s4, s5
    s_lshl_b32 s3, s98, 21
    s_lshl_b32 s52, s48, 12
    s_add_u32 s66, s66, s52
    s_lshr_b32 s5, s2, 6
    s_lshl_b32 s5, s5, 3
    s_add_u32 s5, s5, s49
    s_lshl_b32 s5, s5, 21
    s_and_b32 s4, s50, 7
    s_lshl_b32 s4, s4, 14
    s_add_u32 s4, s4, s5
    s_add_u32 s4, s4, s52
    s_lshl_b32 s5, s49, 5
    s_add_u32 s24, s5, s50
    s_add_u32 s4, s4, 1572864
    s_add_u32 s20, s82, s4
    s_addc_u32 s21, s83, 0
    s_mov_b32 s22, 397312
    s_mov_b32 s23, 0x20000
    s_add_u32 s12, s72, s3
    s_addc_u32 s13, s73, 0
    s_mov_b32 s14, 2097152
    s_mov_b32 s15, 0x20000
    s_add_u32 s16, s80, s4
    s_addc_u32 s17, s81, 0
    s_mov_b32 s18, 397312
    s_mov_b32 s19, 0x20000
    s_add_u32 s8, s70, s3
    s_addc_u32 s9, s71, 0
    s_mov_b32 s10, 2097152
    s_mov_b32 s11, 0x20000
    s_mov_b32 s36, s92
    s_mov_b32 s37, s93
    s_mov_b32 s38, 3866624
    s_mov_b32 s39, 0x20000
    s_mov_b32 s40, s90
    s_mov_b32 s41, s91
    s_mov_b32 s42, 256
    s_mov_b32 s43, 0x20000
    s_mov_b32 s44, s88
    s_mov_b32 s45, s89
    s_mov_b32 s46, 8192
    s_mov_b32 s47, 0x20000
    s_and_b32 s3, s98, 7
    s_lshr_b32 s4, s98, 3
    s_lshl_b32 s5, s3, 5
    s_lshl_b32 s6, s4, 3
    s_add_u32 s5, s5, s6
    s_add_u32 s60, s5, s99
    s_lshl_b32 s5, s4, 16
    s_lshl_b32 s6, s3, 11
    s_add_u32 s5, s5, s6
    s_lshl_b32 s6, s48, 9
    s_add_u32 s58, s5, s6
    s_lshr_b32 s58, s58, 1
    s_and_b32 s3, s2, 3
    s_bfe_u32 s7, s2, 0x10002
    s_cmp_eq_u32 s7, 0
    s_cselect_b32 s28, s76, s86
    s_cselect_b32 s29, s77, s87
    s_and_b32 s4, s50, 3
    s_lshr_b32 s49, s2, 5
    s_lshl_b32 s5, s7, 3
    s_add_u32 s61, s5, s49
    s_mov_b32 s5, s50
    s_lshl_b32 s6, s7, 2
    s_add_u32 s6, s6, s3
    s_lshl_b32 s51, s6, 16
    s_add_u32 s51, s51, 3145728
    s_lshl_b32 s52, s5, 11
    s_add_u32 s62, s51, s52
    s_lshl_b32 s52, s5, 6
    s_add_u32 s63, s51, s52
    s_lshl_b32 s6, s6, 8
    s_lshl_b32 s52, s5, 3
    s_add_u32 s64, s6, s52
    s_lshl_b32 s5, s49, 9
    s_lshl_b32 s6, s48, 5
    s_add_u32 s5, s5, s6
    s_add_u32 s5, s5, s4
    s_lshl_b32 s5, s5, 10
    s_lshl_b32 s6, s3, 8
    s_add_u32 s5, s5, s6
    s_add_u32 s28, s28, s5
    s_addc_u32 s29, s29, 0
    s_sub_u32 s30, 4194304, s5
    s_mov_b32 s31, 0x20000
    v_lshlrev_b32 v125, 2, v123
    v_xor_b32 v125, v125, v124
    v_and_b32 v4, 16, v0
    v_lshl_add_u32 v125, v4, 8, v125
    v_and_b32 v4, 32, v0
    v_lshl_add_u32 v125, v4, 12, v125
    v_lshl_add_u32 v186, v123, 11, v124
    s_lshl_b32 s5, s61, 2
    s_add_u32 s5, s5, s48
    s_lshl_b32 s6, s5, 8
    s_add_u32 s6, s6, 262144
    v_lshlrev_b32 v4, 2, v123
    v_lshl_add_u32 v4, v6, 4, v4
    v_add_u32 v126, s6, v4
    s_and_b32 s5, s5, 31
    s_lshl_b32 s5, s5, 3
    s_lshr_b32 s6, s5, 7
    s_lshl_b32 s6, s6, 17
    s_and_b32 s5, s5, 127
    s_lshl_b32 s5, s5, 8
    s_add_u32 s5, s5, s6
    s_lshl_b32 s6, s4, 15
    s_add_u32 s5, s5, s6
    s_cmp_eq_u32 s7, 0
    s_cselect_b32 s6, 0, 4
    s_lshl_b32 s6, s6, 18
    s_add_u32 s5, s5, s6
    s_add_u32 s5, s5, 1048576
    v_add_u32 v127, s5, v2
    s_add_u32 s5, s5, 524288
    v_add_u32 v4, s5, v124
    s_cmp_eq_u32 s7, 0
    s_cselect_b64 vcc, -1, 0
    v_cndmask_b32 v126, v4, v126, vcc
    s_lshr_b32 s5, s60, 7
    s_lshl_b32 s5, s5, 17
    s_and_b32 s4, s60, 127
    s_lshl_b32 s4, s4, 8
    s_add_u32 s4, s4, s5
    s_add_u32 s4, s4, 1048576
    v_add_u32 v171, s4, v186
    s_lshr_b32 s5, s60, 3
    s_lshl_b32 s5, s5, 8
    s_lshl_b32 s6, s99, 13
    s_add_u32 s5, s5, s6
    s_add_u32 s5, s5, 262144
    s_mul_i32 s3, s98, 256
    s_add_u32 s3, s3, 3670016
    s_cmp_eq_u32 s99, 2
    s_cselect_b32 s6, 1, 0
    s_cselect_b32 s5, s3, s5
    s_cmp_lt_u32 s99, 2
    s_cselect_b32 s6, 16, s6
    s_add_u32 s56, s4, 1572096
    s_cmp_eq_u32 s99, 3
    s_cselect_b32 s6, 64, s6
    s_cselect_b32 s5, s56, s5
    s_cmp_eq_u32 s48, 1
    s_cselect_b32 s6, s6, 0
    s_cmp_eq_u32 s48, 0
    s_cselect_b32 s6, 64, s6
    s_cselect_b32 s5, s4, s5
    s_cmp_eq_u32 s6, 0
    s_cbranch_scc1 L_noclr
    v_mov_b32 v88, -1
    v_mov_b32 v89, -1
    v_mov_b32 v90, -1
    v_mov_b32 v91, -1
    v_mov_b32 v5, 2147483632
    v_cmp_gt_u32 vcc, s6, v0
    s_nop 1
    v_cndmask_b32 v5, v5, v186, vcc
    buffer_store_dwordx4 v[88:91], v5, s[36:39], s5 offen sc1
    s_nop 1
L_noclr:
    s_waitcnt vmcnt(5)
    s_mov_b32 s53, 0
    buffer_load_dwordx4 v[192:195], v2, s[20:23], s53 offen offset:0 nt
    s_waitcnt vmcnt(5)
    buffer_load_dwordx4 v[196:199], v2, s[20:23], s53 offen offset:1024 nt
    s_waitcnt vmcnt(5)
    buffer_load_dwordx4 v[200:203], v2, s[20:23], s53 offen offset:2048 nt
    s_waitcnt vmcnt(5)
    buffer_load_dwordx4 v[204:207], v2, s[20:23], s53 offen offset:3072 nt
    s_waitcnt vmcnt(5)
    s_mov_b32 s53, 131072
    buffer_load_dwordx4 v[208:211], v2, s[20:23], s53 offen offset:0 nt
    s_waitcnt vmcnt(5)
    buffer_load_dwordx4 v[212:215], v2, s[20:23], s53 offen offset:1024 nt
    s_mov_b32 s97, 0
    s_cmp_lg_u32 s2, 0
    s_cbranch_scc1 L_notag
    s_mov_b32 s5, 3145728
    s_load_dwordx4 s[88:91], s[36:37], s5 glc
    s_load_dword s92, s[68:69], 0
    s_load_dword s93, s[70:71], 0
    s_load_dword s94, s[72:73], 0
    s_load_dword s95, s[78:79], 0
    s_waitcnt lgkmcnt(0)
    s_and_b32 s5, s88, 0xff
    s_lshl_b32 s5, s5, 0
    s_or_b32 s97, s97, s5
    s_and_b32 s5, s89, 0xff
    s_lshl_b32 s5, s5, 8
    s_or_b32 s97, s97, s5
    s_and_b32 s5, s90, 0xff
    s_lshl_b32 s5, s5, 16
    s_or_b32 s97, s97, s5
    s_and_b32 s5, s91, 0xff
    s_lshl_b32 s5, s5, 24
    s_or_b32 s97, s97, s5
    s_mov_b32 s5, 0x2b5d1f07
    s_xor_b32 s5, s5, s92
    s_mul_i32 s5, s5, 0x9e3779b1
    s_xor_b32 s5, s5, s93
    s_mul_i32 s5, s5, 0x9e3779b1
    s_xor_b32 s5, s5, s94
    s_mul_i32 s5, s5, 0x9e3779b1
    s_xor_b32 s5, s5, s95
    s_mul_i32 s5, s5, 0x9e3779b1
    s_lshr_b32 s6, s5, 15
    s_xor_b32 s5, s5, s6
    s_and_b32 s5, s5, 0x7e7e7e7e
    s_or_b32 s5, s5, 0x01010101
    s_add_u32 s97, s97, s5
L_notag:
    s_lshr_b32 s5, s60, 3
    s_lshl_b32 s5, s5, 8
    s_and_b32 s6, s99, 3
    s_lshl_b32 s6, s6, 6
    s_add_u32 s5, s5, s6
    s_lshr_b32 s6, s99, 2
    s_lshl_b32 s6, s6, 3
    s_add_u32 s5, s5, s6
    s_add_u32 s4, s5, 262144
    s_cmp_eq_u32 s48, 0
    s_cselect_b32 s6, 4, 0
    v_mov_b32 v5, 2147483632
    v_cmp_gt_u32 vcc, s6, v0
    s_nop 1
    v_cndmask_b32 v168, v5, v2, vcc
    s_getreg_b32 s5, hwreg(HW_REG_XCC_ID, 0, 4)
    s_mul_i32 s6, s5, s5
    s_lshl_b32 s6, s6, 18
    s_lshl_b32 s5, s5, 8
    s_add_u32 s5, s5, s6
    s_add_u32 s55, s5, 1
    v_mov_b32 v8, 0x0c0c0c0c
    v_mov_b32 v4, 202113280
    v_cmp_eq_u32 vcc, 0, v6
    s_nop 1
    v_cndmask_b32 v8, v8, v4, vcc
    v_mov_b32 v4, 16780300
    v_cmp_eq_u32 vcc, 1, v6
    s_nop 1
    v_cndmask_b32 v8, v8, v4, vcc
    v_mov_b32 v9, 0x0c0c0c0c
    v_mov_b32 v4, 202113280
    v_cmp_eq_u32 vcc, 2, v6
    s_nop 1
    v_cndmask_b32 v9, v9, v4, vcc
    v_mov_b32 v4, 16780300
    v_cmp_eq_u32 vcc, 3, v6
    s_nop 1
    v_cndmask_b32 v9, v9, v4, vcc
    v_mov_b32 v10, 0x0c0c0c0c
    v_mov_b32 v4, 202113794
    v_cmp_eq_u32 vcc, 0, v6
    s_nop 1
    v_cndmask_b32 v10, v10, v4, vcc
    v_mov_b32 v4, 50465804
    v_cmp_eq_u32 vcc, 1, v6
    s_nop 1
    v_cndmask_b32 v10, v10, v4, vcc
    v_mov_b32 v11, 0x0c0c0c0c
    v_mov_b32 v4, 202113794
    v_cmp_eq_u32 vcc, 2, v6
    s_nop 1
    v_cndmask_b32 v11, v11, v4, vcc
    v_mov_b32 v4, 50465804
    v_cmp_eq_u32 vcc, 3, v6
    s_nop 1
    v_cndmask_b32 v11, v11, v4, vcc
    s_mov_b32 s54, 1040356334
    s_mov_b32 s65, 1024
    s_lshl_b32 s5, s48, 11
    v_add_u32 v120, s5, v2
    v_lshlrev_b32 v121, 3, v3
    v_lshl_add_u32 v122, v3, 8, v123
    v_add_u32 v122, s57, v122
    s_lshl_b32 s5, s48, 5
    v_add_u32 v176, s5, v121
    s_lshl_b32 s5, s48, 8
    v_lshrrev_b32 v172, 2, v123
    v_add3_u32 v172, v172, v124, s5
    v_subrev_u32 v173, s57, v122
    v_xor_b32 v174, s48, v6
    v_lshl_add_u32 v174, v174, 6, v121
    v_lshl_add_u32 v174, v6, 8, v174
    v_lshl_add_u32 v174, v123, 7, v174
    v_add_u32 v174, 29696, v174
    v_add_u32 v177, 65536, v174
    v_lshlrev_b32 v175, 2, v123
    v_lshl_add_u32 v175, v3, 4, v175
    s_lshl_b32 s5, s48, 9
    s_add_u32 s5, s5, s62
    v_add_u32 v175, s5, v175
    v_and_b32 v185, 7, v0
    v_lshl_add_u32 v185, v185, 6, s5
    v_mov_b32 v5, 2147479536
    v_cmp_eq_u32 vcc, 0, v6
    s_nop 1
    v_cndmask_b32 v175, v5, v175, vcc
    v_lshrrev_b32 v178, 2, v0
    v_lshlrev_b32 v178, 11, v178
    v_lshl_add_u32 v178, v3, 4, v178
    v_lshrrev_b32 v179, 5, v0
    v_bfe_u32 v4, v0, 4, 1
    v_lshl_add_u32 v179, v4, 1, v179
    v_lshlrev_b32 v179, 1, v179
    v_lshl_add_u32 v179, v3, 11, v179
    v_cndmask_b32 v179, v5, v179, vcc
    v_lshl_add_u32 v1, v3, 10, v123
    v_lshl_add_u32 v1, v6, 8, v1
    v_lshlrev_b32 v4, 2, v123
    v_xor_b32 v4, v4, v2
    v_xor_b32 v128, 0, v4
    v_xor_b32 v129, 16, v4
    v_xor_b32 v130, 32, v4
    v_xor_b32 v131, 48, v4
    v_lshlrev_b32 v4, 4, v3
    v_xor_b32 v4, v4, v123
    v_lshl_add_u32 v4, v6, 6, v4
    v_lshl_add_u32 v4, v6, 8, v4
    v_lshl_add_u32 v4, v3, 10, v4
    v_xor_b32 v132, 0, v4
    v_add_u32 v132, s57, v132
    v_xor_b32 v133, 64, v4
    v_add_u32 v133, s57, v133
    v_xor_b32 v134, 128, v4
    v_add_u32 v134, s57, v134
    v_xor_b32 v135, 192, v4
    v_add_u32 v135, s57, v135
    v_mov_b32 v4, 0
    ds_write_b32 v121, v4 offset:4352
    s_waitcnt lgkmcnt(0)
    s_barrier
    s_waitcnt vmcnt(5)
    buffer_load_dwordx4 v[216:219], v2, s[20:23], s53 offen offset:2048 nt
    v_mul_u32_u24 v4, 68, v123
    v_lshl_add_u32 v4, v6, 7, v4
    v_add3_u32 v4, v4, v121, s57
    v_and_b32 v5, 8, v0
    v_lshlrev_b32 v5, 2, v5
    v_sub_u32 v7, v4, v5
    v_add_u32 v4, v4, v5
    ds_read_b128 v[48:51], v122 offset:8704
    ds_read_b128 v[52:55], v122 offset:8768
    ds_read_b64_tr_b16 v[88:89], v4 offset:0
    ds_read_b64_tr_b16 v[90:91], v4 offset:512
    ds_read_b64_tr_b16 v[92:93], v7 offset:32
    ds_read_b64_tr_b16 v[94:95], v7 offset:544
    ds_read_b64_tr_b16 v[96:97], v4 offset:64
    ds_read_b64_tr_b16 v[98:99], v4 offset:576
    ds_read_b64_tr_b16 v[100:101], v7 offset:96
    ds_read_b64_tr_b16 v[102:103], v7 offset:608
    ds_read_b64_tr_b16 v[104:105], v4 offset:4352
    ds_read_b64_tr_b16 v[106:107], v4 offset:4864
    ds_read_b64_tr_b16 v[108:109], v7 offset:4384
    ds_read_b64_tr_b16 v[110:111], v7 offset:4896
    ds_read_b64_tr_b16 v[112:113], v4 offset:4416
    ds_read_b64_tr_b16 v[114:115], v4 offset:4928
    ds_read_b64_tr_b16 v[116:117], v7 offset:4448
    ds_read_b64_tr_b16 v[118:119], v7 offset:4960
    s_waitcnt vmcnt(5)
    buffer_load_dwordx4 v[220:223], v2, s[20:23], s53 offen offset:3072 nt
    s_lshl_b32 s5, s48, 10
    v_add_u32 v4, s5, v173
    s_waitcnt lgkmcnt(0)
    v_mfma_f32_16x16x32_bf16 v[72:75], v[88:91], v[48:51], 0
    v_mfma_f32_16x16x32_bf16 v[76:79], v[92:95], v[48:51], 0
    v_mfma_f32_16x16x32_bf16 v[80:83], v[96:99], v[48:51], 0
    v_mfma_f32_16x16x32_bf16 v[84:87], v[100:103], v[48:51], 0
    v_mfma_f32_16x16x32_bf16 v[72:75], v[104:107], v[52:55], v[72:75]
    v_mfma_f32_16x16x32_bf16 v[76:79], v[108:111], v[52:55], v[76:79]
    v_mfma_f32_16x16x32_bf16 v[80:83], v[112:115], v[52:55], v[80:83]
    v_mfma_f32_16x16x32_bf16 v[84:87], v[116:119], v[52:55], v[84:87]
    s_mov_b32 exec_lo, 0x000f000f
    s_mov_b32 exec_hi, 0x000f000f
    s_nop 2
    ds_write_b128 v4, v[72:75] offset:0
    ds_write_b128 v4, v[76:79] offset:64
    ds_write_b128 v4, v[80:83] offset:128
    ds_write_b128 v4, v[84:87] offset:192
    s_mov_b64 exec, -1
    v_mov_b32 v4, 0
    v_mov_b32 v5, 1
    s_mov_b64 exec, 1
    ds_add_rtn_u32 v5, v4, v5 offset:4352
    s_mov_b64 exec, -1
    s_waitcnt vmcnt(5)
    s_mov_b32 s53, 262144
    buffer_load_dwordx4 v[224:227], v2, s[20:23], s53 offen offset:0 nt
    s_waitcnt lgkmcnt(0)
    v_readfirstlane_b32 s5, v5
    s_nop 0
    s_cmp_lg_u32 s5, 3
    s_cselect_b32 s7, 0, 1
    s_nop 1
    s_cbranch_scc1 L_q_skip
    ds_read_b128 v[88:91], v2 offset:0
    ds_read_b128 v[92:95], v2 offset:1024
    ds_read_b128 v[96:99], v2 offset:2048
    ds_read_b128 v[100:103], v2 offset:3072
    v_lshl_add_u32 v4, v123, 12, v124
    s_waitcnt lgkmcnt(0)
    v_pk_add_f32 v[88:89], v[88:89], v[92:93]
    v_pk_add_f32 v[96:97], v[96:97], v[100:101]
    v_pk_add_f32 v[90:91], v[90:91], v[94:95]
    v_pk_add_f32 v[98:99], v[98:99], v[102:103]
    v_pk_add_f32 v[88:89], v[88:89], v[96:97]
    v_pk_add_f32 v[90:91], v[90:91], v[98:99]
    v_lshrrev_b32 v4, 1, v4
    v_cvt_pk_bf16_f32 v88, v88, v89
    v_cvt_pk_bf16_f32 v89, v90, v91
    v_and_b32 v5, 1, v0
    v_lshl_add_u32 v4, v5, 30, v4
    v_mov_b32_dpp v90, v88 quad_perm:[1,1,3,3] row_mask:0xf bank_mask:0xf
    v_mov_b32_dpp v91, v89 quad_perm:[1,1,3,3] row_mask:0xf bank_mask:0xf
    buffer_store_dwordx4 v[88:91], v4, s[36:39], s59 offen sc1
    s_nop 1
L_q_skip:
    s_waitcnt vmcnt(5)
    buffer_load_dwordx4 v[228:231], v2, s[20:23], s53 offen offset:1024 nt
    s_waitcnt vmcnt(5)
    buffer_load_dwordx4 v[232:235], v2, s[20:23], s53 offen offset:2048 nt
    s_waitcnt vmcnt(5)
    buffer_load_dwordx4 v[236:239], v2, s[20:23], s53 offen offset:3072 nt
    s_waitcnt vmcnt(5)
    s_mov_b32 s53, 393216
    buffer_load_dwordx4 v[240:243], v2, s[20:23], s53 offen offset:0 nt
    s_waitcnt vmcnt(5)
    buffer_load_dwordx4 v[244:247], v2, s[20:23], s53 offen offset:1024 nt
    s_waitcnt vmcnt(5)
    buffer_load_dwordx4 v[248:251], v2, s[20:23], s53 offen offset:2048 nt
    s_waitcnt vmcnt(5)
    buffer_load_dwordx4 v[252:255], v2, s[20:23], s53 offen offset:3072 nt
    s_cmp_eq_u32 s7, 0
    s_nop 0
    s_cbranch_scc1 L_f_skip
    s_and_b32 s5, s2, 7
    s_lshl_b32 s5, s5, 5
    s_mov_b32 s96, s55
    s_atomic_add_x2 s[96:97], s[40:41], s5
L_f_skip:
    s_barrier
    s_waitcnt vmcnt(5)
    s_add_u32 s53, s66, 0
    buffer_load_dwordx4 a[0:3], v2, s[12:15], s53 offen offset:0 nt
    s_waitcnt vmcnt(5)
    buffer_load_dwordx4 a[4:7], v2, s[12:15], s53 offen offset:1024 nt
    s_waitcnt vmcnt(5)
    buffer_load_dwordx4 a[8:11], v2, s[12:15], s53 offen offset:2048 nt
    s_waitcnt vmcnt(5)
    buffer_load_dwordx4 a[12:15], v2, s[12:15], s53 offen offset:3072 nt
    s_waitcnt vmcnt(5)
    s_add_u32 s53, s66, 131072
    buffer_load_dwordx4 a[16:19], v2, s[12:15], s53 offen offset:0 nt
    s_waitcnt vmcnt(5)
    buffer_load_dwordx4 a[20:23], v2, s[12:15], s53 offen offset:1024 nt
    s_waitcnt vmcnt(5)
    buffer_load_dwordx4 a[24:27], v2, s[12:15], s53 offen offset:2048 nt
    s_waitcnt vmcnt(5)
    buffer_load_dwordx4 a[28:31], v2, s[12:15], s53 offen offset:3072 nt
    s_barrier
    s_waitcnt vmcnt(5)
    s_add_u32 s53, s66, 262144
    buffer_load_dwordx4 a[32:35], v2, s[12:15], s53 offen offset:0 nt
    s_waitcnt vmcnt(5)
    buffer_load_dwordx4 a[36:39], v2, s[12:15], s53 offen offset:1024 nt
    s_waitcnt vmcnt(5)
    buffer_load_dwordx4 a[40:43], v2, s[12:15], s53 offen offset:2048 nt
    s_waitcnt vmcnt(5)
    buffer_load_dwordx4 a[44:47], v2, s[12:15], s53 offen offset:3072 nt
    s_waitcnt vmcnt(5)
    s_add_u32 s53, s66, 393216
    buffer_load_dwordx4 a[48:51], v2, s[12:15], s53 offen offset:0 nt
    s_waitcnt vmcnt(5)
    buffer_load_dwordx4 a[52:55], v2, s[12:15], s53 offen offset:1024 nt
    s_waitcnt vmcnt(5)
    buffer_load_dwordx4 a[56:59], v2, s[12:15], s53 offen offset:2048 nt
    s_waitcnt vmcnt(5)
    buffer_load_dwordx4 a[60:63], v2, s[12:15], s53 offen offset:3072 nt
    s_barrier
    s_waitcnt vmcnt(5)
    s_add_u32 s53, s66, 524288
    buffer_load_dwordx4 a[64:67], v2, s[12:15], s53 offen offset:0 nt
    s_waitcnt vmcnt(5)
    buffer_load_dwordx4 a[68:71], v2, s[12:15], s53 offen offset:1024 nt
    s_waitcnt vmcnt(5)
    buffer_load_dwordx4 a[72:75], v2, s[12:15], s53 offen offset:2048 nt
    s_waitcnt vmcnt(5)
    buffer_load_dwordx4 a[76:79], v2, s[12:15], s53 offen offset:3072 nt
    s_waitcnt vmcnt(5)
    s_add_u32 s53, s66, 655360
    buffer_load_dwordx4 a[80:83], v2, s[12:15], s53 offen offset:0 nt
    s_waitcnt vmcnt(5)
    buffer_load_dwordx4 a[84:87], v2, s[12:15], s53 offen offset:1024 nt
    s_waitcnt vmcnt(5)
    buffer_load_dwordx4 a[88:91], v2, s[12:15], s53 offen offset:2048 nt
    s_waitcnt vmcnt(5)
    buffer_load_dwordx4 a[92:95], v2, s[12:15], s53 offen offset:3072 nt
    s_barrier
    s_waitcnt vmcnt(5)
    s_add_u32 s53, s66, 786432
    buffer_load_dwordx4 a[96:99], v2, s[12:15], s53 offen offset:0 nt
    s_waitcnt vmcnt(5)
    buffer_load_dwordx4 a[100:103], v2, s[12:15], s53 offen offset:1024 nt
    s_waitcnt vmcnt(5)
    buffer_load_dwordx4 a[104:107], v2, s[12:15], s53 offen offset:2048 nt
    s_waitcnt vmcnt(5)
    buffer_load_dwordx4 a[108:111], v2, s[12:15], s53 offen offset:3072 nt
    s_waitcnt vmcnt(5)
    s_add_u32 s53, s66, 917504
    buffer_load_dwordx4 a[112:115], v2, s[12:15], s53 offen offset:0 nt
    s_waitcnt vmcnt(5)
    buffer_load_dwordx4 a[116:119], v2, s[12:15], s53 offen offset:1024 nt
    s_waitcnt vmcnt(5)
    buffer_load_dwordx4 a[120:123], v2, s[12:15], s53 offen offset:2048 nt
    s_waitcnt vmcnt(5)
    buffer_load_dwordx4 a[124:127], v2, s[12:15], s53 offen offset:3072 nt
    s_barrier
    s_waitcnt vmcnt(5)
    s_add_u32 s53, s66, 1048576
    buffer_load_dwordx4 a[128:131], v2, s[12:15], s53 offen offset:0 nt
    s_waitcnt vmcnt(5)
    buffer_load_dwordx4 a[132:135], v2, s[12:15], s53 offen offset:1024 nt
    s_waitcnt vmcnt(5)
    buffer_load_dwordx4 a[136:139], v2, s[12:15], s53 offen offset:2048 nt
    s_waitcnt vmcnt(5)
    buffer_load_dwordx4 a[140:143], v2, s[12:15], s53 offen offset:3072 nt
    s_waitcnt vmcnt(5)
    s_add_u32 s53, s66, 1179648
    buffer_load_dwordx4 a[144:147], v2, s[12:15], s53 offen offset:0 nt
    s_waitcnt vmcnt(5)
    buffer_load_dwordx4 a[148:151], v2, s[12:15], s53 offen offset:1024 nt
    s_waitcnt vmcnt(5)
    buffer_load_dwordx4 a[152:155], v2, s[12:15], s53 offen offset:2048 nt
    s_waitcnt vmcnt(5)
    buffer_load_dwordx4 a[156:159], v2, s[12:15], s53 offen offset:3072 nt
    s_barrier
    s_waitcnt vmcnt(5)
    s_add_u32 m0, s57, 0
    s_mov_b32 s53, 0
    buffer_load_dwordx4 v128, s[16:19], s53 offen offset:0 nt lds
    s_waitcnt vmcnt(5)
    buffer_load_dwordx4 v129, s[16:19], s53 offen offset:1024 nt lds
    v_and_b32 v4, 7, v0
    v_lshlrev_b32 v4, 5, v4
    buffer_load_dwordx2 v[180:181], v4, s[40:43], 0 offen sc1
    s_waitcnt vmcnt(5)
    buffer_load_dwordx4 v130, s[16:19], s53 offen offset:2048 nt lds
    s_waitcnt vmcnt(5)
    buffer_load_dwordx4 v131, s[16:19], s53 offen offset:3072 nt lds
    s_waitcnt vmcnt(5)
    s_add_u32 m0, s57, 4096
    s_mov_b32 s53, 131072
    buffer_load_dwordx4 v128, s[16:19], s53 offen offset:0 nt lds
    s_waitcnt vmcnt(5)
    buffer_load_dwordx4 v129, s[16:19], s53 offen offset:1024 nt lds
    s_waitcnt vmcnt(5)
    buffer_load_dwordx4 v130, s[16:19], s53 offen offset:2048 nt lds
    s_waitcnt vmcnt(5)
    buffer_load_dwordx4 v131, s[16:19], s53 offen offset:3072 nt lds
    v_and_b32 v5, 0xff, v180
    v_cmp_gt_u32 vcc, 32, v5
    s_nop 0
    s_cbranch_vccnz L_p0_slow
L_p0_ok:
    s_and_b32 s5, s2, 7
    v_readlane_b32 s5, v180, s5
    s_lshl_b32 s6, s55, 5
    s_cmp_eq_u32 s5, s6
    s_cselect_b32 s55, 1, 0
    v_readfirstlane_b32 s5, v181
    s_nop 1
    v_mov_b32 v184, s5
    v_lshrrev_b32 v4, 5, v0
    s_lshr_b32 s5, s2, 6
    s_lshl_b32 s5, s5, 15
    s_and_b32 s6, s2, 7
    s_lshl_b32 s6, s6, 10
    s_add_u32 s5, s5, s6
    s_lshl_b32 s6, s48, 8
    s_add_u32 s5, s5, s6
    s_add_u32 s5, s5, 16384
    s_sub_u32 s5, s5, s58
    v_mul_lo_u32 v4, s5, v4
    v_add_u32 v4, s58, v4
    v_and_b32 v5, 16, v0
    v_lshl_add_u32 v4, v5, 9, v4
    v_add_u32 v4, v4, v124
    buffer_load_dwordx4 v[88:91], v4, s[36:39], 0 offen sc1
    s_barrier
    s_waitcnt vmcnt(5)
    s_add_u32 m0, s57, 8192
    s_mov_b32 s53, 262144
    buffer_load_dwordx4 v128, s[16:19], s53 offen offset:0 nt lds
    s_waitcnt vmcnt(5)
    buffer_load_dwordx4 v129, s[16:19], s53 offen offset:1024 nt lds
    s_waitcnt vmcnt(5)
    buffer_load_dwordx4 v130, s[16:19], s53 offen offset:2048 nt lds
    s_waitcnt vmcnt(5)
    buffer_load_dwordx4 v131, s[16:19], s53 offen offset:3072 nt lds
    s_waitcnt vmcnt(5)
    s_add_u32 m0, s57, 12288
    s_mov_b32 s53, 393216
    buffer_load_dwordx4 v128, s[16:19], s53 offen offset:0 nt lds
    s_waitcnt vmcnt(5)
    buffer_load_dwordx4 v129, s[16:19], s53 offen offset:1024 nt lds
    v_permlane16_swap_b32 v88, v90
    v_permlane16_swap_b32 v89, v91
    v_lshlrev_b32 v92, 16, v88
    v_and_b32 v93, 0xffff0000, v88
    v_lshlrev_b32 v94, 16, v89
    v_and_b32 v95, 0xffff0000, v89
    v_lshlrev_b32 v96, 16, v90
    v_and_b32 v97, 0xffff0000, v90
    v_lshlrev_b32 v98, 16, v91
    v_and_b32 v99, 0xffff0000, v91
    v_pk_add_f32 v[88:89], v[92:93], v[96:97]
    v_pk_add_f32 v[90:91], v[94:95], v[98:99]
    v_lshrrev_b32 v4, 5, v0
    v_lshlrev_b32 v4, 10, v4
    v_bfe_u32 v5, v0, 4, 1
    v_lshl_add_u32 v4, v5, 3, v4
    v_add_u32 v4, v4, v124
    s_lshl_b32 s5, s48, 8
    v_add_u32 v4, s5, v4
    v_cvt_pk_bf16_f32 v88, v88, v89
    v_cvt_pk_bf16_f32 v89, v90, v91
    ds_write_b64 v4, v[88:89] offset:12608
    v_mov_b32 v4, 0
    v_mov_b32 v5, 1
    s_mov_b64 exec, 1
    ds_add_u32 v4, v5 offset:4360
    s_mov_b64 exec, -1
    s_waitcnt vmcnt(5)
    buffer_load_dwordx4 v130, s[16:19], s53 offen offset:2048 nt lds
    s_waitcnt vmcnt(5)
    buffer_load_dwordx4 v131, s[16:19], s53 offen offset:3072 nt lds
    v_mov_b32 v4, 0
L_qw:
    ds_read_b32 v5, v4 offset:4360
    ds_read_b128 v[32:35], v173 offset:13632
    ds_read_b128 v[36:39], v173 offset:13696
    ds_read_b128 v[40:43], v173 offset:13760
    ds_read_b128 v[44:47], v173 offset:13824
    ds_read_b128 v[16:19], v173 offset:12608
    ds_read_b128 v[20:23], v173 offset:12672
    ds_read_b128 v[24:27], v173 offset:12736
    ds_read_b128 v[28:31], v173 offset:12800
    s_waitcnt lgkmcnt(0)
    v_readfirstlane_b32 s5, v5
    s_nop 0
    s_cmp_lt_u32 s5, 4
    s_cbranch_scc1 L_qw
    ds_read_b128 v[136:139], v132 offset:0
    ds_read_b128 v[140:143], v133 offset:0
    ds_read_b128 v[144:147], v134 offset:0
    ds_read_b128 v[148:151], v135 offset:0
    s_waitcnt lgkmcnt(3)
    v_mfma_f32_16x16x32_bf16 v[48:51], v[136:139], v[32:35], 0
    s_waitcnt lgkmcnt(2)
    v_mfma_f32_16x16x32_bf16 v[48:51], v[140:143], v[36:39], v[48:51]
    s_waitcnt lgkmcnt(1)
    v_mfma_f32_16x16x32_bf16 v[48:51], v[144:147], v[40:43], v[48:51]
    s_waitcnt lgkmcnt(0)
    v_mfma_f32_16x16x32_bf16 v[48:51], v[148:151], v[44:47], v[48:51]
    ds_read_b128 v[152:155], v132 offset:4096
    ds_read_b128 v[156:159], v133 offset:4096
    ds_read_b128 v[160:163], v134 offset:4096
    ds_read_b128 v[164:167], v135 offset:4096
    s_waitcnt lgkmcnt(3)
    v_mfma_f32_16x16x32_bf16 v[52:55], v[152:155], v[32:35], 0
    s_waitcnt lgkmcnt(2)
    v_mfma_f32_16x16x32_bf16 v[52:55], v[156:159], v[36:39], v[52:55]
    s_waitcnt lgkmcnt(1)
    v_mfma_f32_16x16x32_bf16 v[52:55], v[160:163], v[40:43], v[52:55]
    s_waitcnt lgkmcnt(0)
    v_mfma_f32_16x16x32_bf16 v[52:55], v[164:167], v[44:47], v[52:55]
    s_barrier
    s_waitcnt vmcnt(5)
    s_add_u32 m0, s57, 16384
    s_add_u32 s53, s66, 0
    buffer_load_dwordx4 v128, s[8:11], s53 offen offset:0 nt lds
    s_waitcnt vmcnt(5)
    buffer_load_dwordx4 v129, s[8:11], s53 offen offset:1024 nt lds
    s_waitcnt vmcnt(5)
    buffer_load_dwordx4 v130, s[8:11], s53 offen offset:2048 nt lds
    s_waitcnt vmcnt(5)
    buffer_load_dwordx4 v131, s[8:11], s53 offen offset:3072 nt lds
    ds_read_b128 v[136:139], v132 offset:8192
    ds_read_b128 v[140:143], v133 offset:8192
    ds_read_b128 v[144:147], v134 offset:8192
    ds_read_b128 v[148:151], v135 offset:8192
    s_waitcnt lgkmcnt(3)
    v_mfma_f32_16x16x32_bf16 v[56:59], v[136:139], v[32:35], 0
    s_waitcnt lgkmcnt(2)
    v_mfma_f32_16x16x32_bf16 v[56:59], v[140:143], v[36:39], v[56:59]
    s_waitcnt lgkmcnt(1)
    v_mfma_f32_16x16x32_bf16 v[56:59], v[144:147], v[40:43], v[56:59]
    s_waitcnt lgkmcnt(0)
    v_mfma_f32_16x16x32_bf16 v[56:59], v[148:151], v[44:47], v[56:59]
    s_waitcnt vmcnt(5)
    s_add_u32 m0, s57, 20480
    s_add_u32 s53, s66, 131072
    buffer_load_dwordx4 v128, s[8:11], s53 offen offset:0 nt lds
    s_waitcnt vmcnt(5)
    buffer_load_dwordx4 v129, s[8:11], s53 offen offset:1024 nt lds
    s_waitcnt vmcnt(5)
    buffer_load_dwordx4 v130, s[8:11], s53 offen offset:2048 nt lds
    s_waitcnt vmcnt(5)
    buffer_load_dwordx4 v131, s[8:11], s53 offen offset:3072 nt lds
    ds_read_b128 v[152:155], v132 offset:12288
    ds_read_b128 v[156:159], v133 offset:12288
    ds_read_b128 v[160:163], v134 offset:12288
    ds_read_b128 v[164:167], v135 offset:12288
    s_waitcnt lgkmcnt(3)
    v_mfma_f32_16x16x32_bf16 v[60:63], v[152:155], v[32:35], 0
    s_waitcnt lgkmcnt(2)
    v_mfma_f32_16x16x32_bf16 v[60:63], v[156:159], v[36:39], v[60:63]
    s_waitcnt lgkmcnt(1)
    v_mfma_f32_16x16x32_bf16 v[60:63], v[160:163], v[40:43], v[60:63]
    s_waitcnt lgkmcnt(0)
    v_mfma_f32_16x16x32_bf16 v[60:63], v[164:167], v[44:47], v[60:63]
    v_max3_f32 v88, v48, v49, v50
    v_max3_f32 v89, v51, v52, v53
    v_max3_f32 v90, v54, v55, v56
    v_max3_f32 v91, v57, v58, v59
    s_nop 3
    v_max3_f32 v92, v60, v61, v62
    v_max3_f32 v93, v88, v89, v90
    v_max3_f32 v94, v91, v92, v63
    v_max_f32 v14, v93, v94
    v_mov_b32 v88, v14
    s_nop 1
    v_permlane32_swap_b32 v14, v88
    v_max_f32 v14, v14, v88
    v_mov_b32 v88, v14
    s_nop 1
    v_permlane16_swap_b32 v14, v88
    v_max_f32 v14, v14, v88
    v_mul_f32 v12, s54, v14
    v_fma_f32 v48, v48, s54, -v12
    v_fma_f32 v49, v49, s54, -v12
    v_fma_f32 v50, v50, s54, -v12
    v_fma_f32 v51, v51, s54, -v12
    v_fma_f32 v52, v52, s54, -v12
    v_fma_f32 v53, v53, s54, -v12
    v_fma_f32 v54, v54, s54, -v12
    v_fma_f32 v55, v55, s54, -v12
    v_exp_f32 v48, v48
    v_exp_f32 v49, v49
    v_exp_f32 v50, v50
    v_exp_f32 v51, v51
    v_exp_f32 v52, v52
    v_exp_f32 v53, v53
    v_exp_f32 v54, v54
    v_exp_f32 v55, v55
    v_add_f32 v88, v48, v49
    v_add_f32 v89, v50, v51
    v_add_f32 v90, v52, v53
    v_add_f32 v91, v54, v55
    v_add_f32 v92, v88, v89
    v_add_f32 v93, v90, v91
    v_add_f32 v13, v92, v93
    v_cvt_pk_bf16_f32 v64, v48, v49
    v_cvt_pk_bf16_f32 v65, v50, v51
    v_cvt_pk_bf16_f32 v66, v52, v53
    v_cvt_pk_bf16_f32 v67, v54, v55
    v_fma_f32 v56, v56, s54, -v12
    v_fma_f32 v57, v57, s54, -v12
    v_fma_f32 v58, v58, s54, -v12
    v_fma_f32 v59, v59, s54, -v12
    v_fma_f32 v60, v60, s54, -v12
    v_fma_f32 v61, v61, s54, -v12
    v_fma_f32 v62, v62, s54, -v12
    v_fma_f32 v63, v63, s54, -v12
    v_exp_f32 v56, v56
    v_exp_f32 v57, v57
    v_exp_f32 v58, v58
    v_exp_f32 v59, v59
    v_exp_f32 v60, v60
    v_exp_f32 v61, v61
    v_exp_f32 v62, v62
    v_exp_f32 v63, v63
    v_add_f32 v88, v56, v57
    v_add_f32 v89, v58, v59
    v_add_f32 v90, v60, v61
    v_add_f32 v91, v62, v63
    v_add_f32 v92, v88, v89
    v_add_f32 v93, v90, v91
    v_add_f32 v94, v92, v93
    v_add_f32 v13, v94, v13
    v_cvt_pk_bf16_f32 v68, v56, v57
    v_cvt_pk_bf16_f32 v69, v58, v59
    v_cvt_pk_bf16_f32 v70, v60, v61
    v_cvt_pk_bf16_f32 v71, v62, v63
    s_barrier
    s_waitcnt vmcnt(5)
    s_add_u32 m0, s57, 24576
    s_add_u32 s53, s66, 262144
    buffer_load_dwordx4 v128, s[8:11], s53 offen offset:0 nt lds
    s_waitcnt vmcnt(5)
    buffer_load_dwordx4 v129, s[8:11], s53 offen offset:1024 nt lds
    s_waitcnt vmcnt(5)
    buffer_load_dwordx4 v130, s[8:11], s53 offen offset:2048 nt lds
    s_waitcnt vmcnt(5)
    buffer_load_dwordx4 v131, s[8:11], s53 offen offset:3072 nt lds
    ds_read_b128 v[136:139], v132 offset:16384
    ds_read_b128 v[140:143], v133 offset:16384
    ds_read_b128 v[144:147], v134 offset:16384
    ds_read_b128 v[148:151], v135 offset:16384
    v_perm_b32 v80, v64, v64, v8
    v_perm_b32 v81, v64, v64, v9
    v_perm_b32 v82, v64, v64, v10
    v_perm_b32 v83, v64, v64, v11
    v_mfma_f32_16x16x16_bf16 v[72:75], v[80:81], v[192:193], 0
    v_mfma_f32_16x16x16_bf16 v[76:79], v[80:81], v[194:195], 0
    v_perm_b32 v84, v65, v65, v8
    v_perm_b32 v85, v65, v65, v9
    v_mfma_f32_16x16x16_bf16 v[72:75], v[82:83], v[196:197], v[72:75]
    v_mfma_f32_16x16x16_bf16 v[76:79], v[82:83], v[198:199], v[76:79]
    v_perm_b32 v86, v65, v65, v10
    v_perm_b32 v87, v65, v65, v11
    v_mfma_f32_16x16x16_bf16 v[72:75], v[84:85], v[200:201], v[72:75]
    v_mfma_f32_16x16x16_bf16 v[76:79], v[84:85], v[202:203], v[76:79]
    v_mfma_f32_16x16x16_bf16 v[72:75], v[86:87], v[204:205], v[72:75]
    v_mfma_f32_16x16x16_bf16 v[76:79], v[86:87], v[206:207], v[76:79]
    s_waitcnt lgkmcnt(0)
    v_mfma_f32_16x16x32_bf16 v[48:51], v[136:139], v[16:19], 0
    v_mfma_f32_16x16x32_bf16 v[48:51], v[140:143], v[20:23], v[48:51]
    v_mfma_f32_16x16x32_bf16 v[48:51], v[144:147], v[24:27], v[48:51]
    v_mfma_f32_16x16x32_bf16 v[48:51], v[148:151], v[28:31], v[48:51]
    s_waitcnt vmcnt(5)
    s_add_u32 m0, s57, 28672
    s_add_u32 s53, s66, 393216
    buffer_load_dwordx4 v128, s[8:11], s53 offen offset:0 nt lds
    s_waitcnt vmcnt(5)
    buffer_load_dwordx4 v129, s[8:11], s53 offen offset:1024 nt lds
    s_waitcnt vmcnt(5)
    buffer_load_dwordx4 v130, s[8:11], s53 offen offset:2048 nt lds
    s_waitcnt vmcnt(5)
    buffer_load_dwordx4 v131, s[8:11], s53 offen offset:3072 nt lds
    ds_read_b128 v[152:155], v132 offset:20480
    ds_read_b128 v[156:159], v133 offset:20480
    ds_read_b128 v[160:163], v134 offset:20480
    ds_read_b128 v[164:167], v135 offset:20480
    v_perm_b32 v80, v66, v66, v8
    v_perm_b32 v81, v66, v66, v9
    v_perm_b32 v82, v66, v66, v10
    v_perm_b32 v83, v66, v66, v11
    v_mfma_f32_16x16x16_bf16 v[72:75], v[80:81], v[208:209], v[72:75]
    v_mfma_f32_16x16x16_bf16 v[76:79], v[80:81], v[210:211], v[76:79]
    v_perm_b32 v84, v67, v67, v8
    v_perm_b32 v85, v67, v67, v9
    v_mfma_f32_16x16x16_bf16 v[72:75], v[82:83], v[212:213], v[72:75]
    v_mfma_f32_16x16x16_bf16 v[76:79], v[82:83], v[214:215], v[76:79]
    v_perm_b32 v86, v67, v67, v10
    v_perm_b32 v87, v67, v67, v11
    v_mfma_f32_16x16x16_bf16 v[72:75], v[84:85], v[216:217], v[72:75]
    v_mfma_f32_16x16x16_bf16 v[76:79], v[84:85], v[218:219], v[76:79]
    v_mfma_f32_16x16x16_bf16 v[72:75], v[86:87], v[220:221], v[72:75]
    v_mfma_f32_16x16x16_bf16 v[76:79], v[86:87], v[222:223], v[76:79]
    s_waitcnt lgkmcnt(0)
    v_mfma_f32_16x16x32_bf16 v[52:55], v[152:155], v[16:19], 0
    v_mfma_f32_16x16x32_bf16 v[52:55], v[156:159], v[20:23], v[52:55]
    v_mfma_f32_16x16x32_bf16 v[52:55], v[160:163], v[24:27], v[52:55]
    v_mfma_f32_16x16x32_bf16 v[52:55], v[164:167], v[28:31], v[52:55]
    s_barrier
    s_waitcnt vmcnt(5)
    s_add_u32 m0, s57, 0
    s_add_u32 s53, s66, 524288
    buffer_load_dwordx4 v128, s[8:11], s53 offen offset:0 nt lds
    s_waitcnt vmcnt(5)
    buffer_load_dwordx4 v129, s[8:11], s53 offen offset:1024 nt lds
    s_waitcnt vmcnt(5)
    buffer_load_dwordx4 v130, s[8:11], s53 offen offset:2048 nt lds
    s_waitcnt vmcnt(5)
    buffer_load_dwordx4 v131, s[8:11], s53 offen offset:3072 nt lds
    ds_read_b128 v[136:139], v132 offset:24576
    ds_read_b128 v[140:143], v133 offset:24576
    ds_read_b128 v[144:147], v134 offset:24576
    ds_read_b128 v[148:151], v135 offset:24576
    v_perm_b32 v80, v68, v68, v8
    v_perm_b32 v81, v68, v68, v9
    v_perm_b32 v82, v68, v68, v10
    v_perm_b32 v83, v68, v68, v11
    v_mfma_f32_16x16x16_bf16 v[72:75], v[80:81], v[224:225], v[72:75]
    v_mfma_f32_16x16x16_bf16 v[76:79], v[80:81], v[226:227], v[76:79]
    v_perm_b32 v84, v69, v69, v8
    v_perm_b32 v85, v69, v69, v9
    v_mfma_f32_16x16x16_bf16 v[72:75], v[82:83], v[228:229], v[72:75]
    v_mfma_f32_16x16x16_bf16 v[76:79], v[82:83], v[230:231], v[76:79]
    v_perm_b32 v86, v69, v69, v10
    v_perm_b32 v87, v69, v69, v11
    v_mfma_f32_16x16x16_bf16 v[72:75], v[84:85], v[232:233], v[72:75]
    v_mfma_f32_16x16x16_bf16 v[76:79], v[84:85], v[234:235], v[76:79]
    v_mfma_f32_16x16x16_bf16 v[72:75], v[86:87], v[236:237], v[72:75]
    v_mfma_f32_16x16x16_bf16 v[76:79], v[86:87], v[238:239], v[76:79]
    s_waitcnt lgkmcnt(0)
    v_mfma_f32_16x16x32_bf16 v[56:59], v[136:139], v[16:19], 0
    v_mfma_f32_16x16x32_bf16 v[56:59], v[140:143], v[20:23], v[56:59]
    v_mfma_f32_16x16x32_bf16 v[56:59], v[144:147], v[24:27], v[56:59]
    v_mfma_f32_16x16x32_bf16 v[56:59], v[148:151], v[28:31], v[56:59]
    s_waitcnt vmcnt(5)
    s_add_u32 m0, s57, 4096
    s_add_u32 s53, s66, 655360
    buffer_load_dwordx4 v128, s[8:11], s53 offen offset:0 nt lds
    s_waitcnt vmcnt(5)
    buffer_load_dwordx4 v129, s[8:11], s53 offen offset:1024 nt lds
    s_waitcnt vmcnt(5)
    buffer_load_dwordx4 v130, s[8:11], s53 offen offset:2048 nt lds
    s_waitcnt vmcnt(5)
    buffer_load_dwordx4 v131, s[8:11], s53 offen offset:3072 nt lds
    ds_read_b128 v[152:155], v132 offset:28672
    ds_read_b128 v[156:159], v133 offset:28672
    ds_read_b128 v[160:163], v134 offset:28672
    ds_read_b128 v[164:167], v135 offset:28672
    v_perm_b32 v80, v70, v70, v8
    v_perm_b32 v81, v70, v70, v9
    v_perm_b32 v82, v70, v70, v10
    v_perm_b32 v83, v70, v70, v11
    v_mfma_f32_16x16x16_bf16 v[72:75], v[80:81], v[240:241], v[72:75]
    v_mfma_f32_16x16x16_bf16 v[76:79], v[80:81], v[242:243], v[76:79]
    v_perm_b32 v84, v71, v71, v8
    v_perm_b32 v85, v71, v71, v9
    v_mfma_f32_16x16x16_bf16 v[72:75], v[82:83], v[244:245], v[72:75]
    v_mfma_f32_16x16x16_bf16 v[76:79], v[82:83], v[246:247], v[76:79]
    v_perm_b32 v86, v71, v71, v10
    v_perm_b32 v87, v71, v71, v11
    v_mfma_f32_16x16x16_bf16 v[72:75], v[84:85], v[248:249], v[72:75]
    v_mfma_f32_16x16x16_bf16 v[76:79], v[84:85], v[250:251], v[76:79]
    v_mfma_f32_16x16x16_bf16 v[72:75], v[86:87], v[252:253], v[72:75]
    v_mfma_f32_16x16x16_bf16 v[76:79], v[86:87], v[254:255], v[76:79]
    s_waitcnt lgkmcnt(0)
    v_mfma_f32_16x16x32_bf16 v[60:63], v[152:155], v[16:19], 0
    v_mfma_f32_16x16x32_bf16 v[60:63], v[156:159], v[20:23], v[60:63]
    v_mfma_f32_16x16x32_bf16 v[60:63], v[160:163], v[24:27], v[60:63]
    v_mfma_f32_16x16x32_bf16 v[60:63], v[164:167], v[28:31], v[60:63]
    v_mov_b32 v88, v13
    s_nop 1
    v_permlane32_swap_b32 v13, v88
    v_add_f32 v13, v13, v88
    v_mov_b32 v88, v13
    s_nop 1
    v_permlane16_swap_b32 v13, v88
    v_add_f32 v13, v13, v88
    ds_write_b64 v176, v[12:13] offset:4096
    ds_write_b128 v120, v[72:75] offset:4416
    ds_write_b128 v120, v[76:79] offset:5440
    v_mov_b32 v4, 0
    v_mov_b32 v5, 1
    s_mov_b64 exec, 1
    ds_add_rtn_u32 v5, v4, v5 offset:4368
    s_mov_b64 exec, -1
    s_waitcnt lgkmcnt(0)
    v_readfirstlane_b32 s5, v5
    s_nop 0
    s_cmp_lg_u32 s5, 3
    s_cselect_b32 s7, 0, 1
    s_nop 1
    s_cbranch_scc1 L_ob_skip
    ds_read_b64 v[80:81], v121 offset:4096
    ds_read_b64 v[82:83], v121 offset:4128
    ds_read_b64 v[84:85], v121 offset:4160
    ds_read_b64 v[86:87], v121 offset:4192
    ds_read_b128 v[88:91], v2 offset:4416
    ds_read_b128 v[92:95], v2 offset:5440
    ds_read_b128 v[96:99], v2 offset:6464
    ds_read_b128 v[100:103], v2 offset:7488
    ds_read_b128 v[104:107], v2 offset:8512
    ds_read_b128 v[108:111], v2 offset:9536
    ds_read_b128 v[112:115], v2 offset:10560
    ds_read_b128 v[116:119], v2 offset:11584
    s_waitcnt lgkmcnt(0)
    v_max3_f32 v182, v80, v82, v84
    v_max_f32 v182, v182, v86
    v_sub_f32 v80, v80, v182
    v_sub_f32 v82, v82, v182
    v_sub_f32 v84, v84, v182
    v_sub_f32 v86, v86, v182
    v_exp_f32 v80, v80
    v_exp_f32 v82, v82
    v_exp_f32 v84, v84
    v_exp_f32 v86, v86
    v_mul_f32 v183, v80, v81
    v_fmac_f32 v183, v82, v83
    v_fmac_f32 v183, v84, v85
    v_fmac_f32 v183, v86, v87
    v_mul_f32_dpp v88, v80, v88 quad_perm:[0,0,0,0] row_mask:0xf bank_mask:0xf
    v_mul_f32_dpp v89, v80, v89 quad_perm:[1,1,1,1] row_mask:0xf bank_mask:0xf
    v_mul_f32_dpp v90, v80, v90 quad_perm:[2,2,2,2] row_mask:0xf bank_mask:0xf
    v_mul_f32_dpp v91, v80, v91 quad_perm:[3,3,3,3] row_mask:0xf bank_mask:0xf
    v_mul_f32_dpp v92, v80, v92 quad_perm:[0,0,0,0] row_mask:0xf bank_mask:0xf
    v_mul_f32_dpp v93, v80, v93 quad_perm:[1,1,1,1] row_mask:0xf bank_mask:0xf
    v_mul_f32_dpp v94, v80, v94 quad_perm:[2,2,2,2] row_mask:0xf bank_mask:0xf
    v_mul_f32_dpp v95, v80, v95 quad_perm:[3,3,3,3] row_mask:0xf bank_mask:0xf
    v_fmac_f32_dpp v88, v82, v96 quad_perm:[0,0,0,0] row_mask:0xf bank_mask:0xf
    v_fmac_f32_dpp v89, v82, v97 quad_perm:[1,1,1,1] row_mask:0xf bank_mask:0xf
    v_fmac_f32_dpp v90, v82, v98 quad_perm:[2,2,2,2] row_mask:0xf bank_mask:0xf
    v_fmac_f32_dpp v91, v82, v99 quad_perm:[3,3,3,3] row_mask:0xf bank_mask:0xf
    v_fmac_f32_dpp v92, v82, v100 quad_perm:[0,0,0,0] row_mask:0xf bank_mask:0xf
    v_fmac_f32_dpp v93, v82, v101 quad_perm:[1,1,1,1] row_mask:0xf bank_mask:0xf
    v_fmac_f32_dpp v94, v82, v102 quad_perm:[2,2,2,2] row_mask:0xf bank_mask:0xf
    v_fmac_f32_dpp v95, v82, v103 quad_perm:[3,3,3,3] row_mask:0xf bank_mask:0xf
    v_fmac_f32_dpp v88, v84, v104 quad_perm:[0,0,0,0] row_mask:0xf bank_mask:0xf
    v_fmac_f32_dpp v89, v84, v105 quad_perm:[1,1,1,1] row_mask:0xf bank_mask:0xf
    v_fmac_f32_dpp v90, v84, v106 quad_perm:[2,2,2,2] row_mask:0xf bank_mask:0xf
    v_fmac_f32_dpp v91, v84, v107 quad_perm:[3,3,3,3] row_mask:0xf bank_mask:0xf
    v_fmac_f32_dpp v92, v84, v108 quad_perm:[0,0,0,0] row_mask:0xf bank_mask:0xf
    v_fmac_f32_dpp v93, v84, v109 quad_perm:[1,1,1,1] row_mask:0xf bank_mask:0xf
    v_fmac_f32_dpp v94, v84, v110 quad_perm:[2,2,2,2] row_mask:0xf bank_mask:0xf
    v_fmac_f32_dpp v95, v84, v111 quad_perm:[3,3,3,3] row_mask:0xf bank_mask:0xf
    v_fmac_f32_dpp v88, v86, v112 quad_perm:[0,0,0,0] row_mask:0xf bank_mask:0xf
    v_fmac_f32_dpp v89, v86, v113 quad_perm:[1,1,1,1] row_mask:0xf bank_mask:0xf
    v_fmac_f32_dpp v90, v86, v114 quad_perm:[2,2,2,2] row_mask:0xf bank_mask:0xf
    v_fmac_f32_dpp v91, v86, v115 quad_perm:[3,3,3,3] row_mask:0xf bank_mask:0xf
    v_fmac_f32_dpp v92, v86, v116 quad_perm:[0,0,0,0] row_mask:0xf bank_mask:0xf
    v_fmac_f32_dpp v93, v86, v117 quad_perm:[1,1,1,1] row_mask:0xf bank_mask:0xf
    v_fmac_f32_dpp v94, v86, v118 quad_perm:[2,2,2,2] row_mask:0xf bank_mask:0xf
    v_fmac_f32_dpp v95, v86, v119 quad_perm:[3,3,3,3] row_mask:0xf bank_mask:0xf
    v_cvt_pk_bf16_f32 v88, v88, v89
    v_cvt_pk_bf16_f32 v89, v90, v91
    v_cvt_pk_bf16_f32 v90, v92, v93
    v_cvt_pk_bf16_f32 v91, v94, v95
    s_lshr_b32 s6, s24, 7
    s_lshl_b32 s6, s6, 17
    s_and_b32 s5, s24, 127
    s_lshl_b32 s5, s5, 8
    s_add_u32 s5, s5, s6
    s_add_u32 s5, s5, 2097152
    s_cmp_eq_u32 s55, 0
    s_cbranch_scc1 L_far1
    buffer_store_dwordx4 v[88:91], v186, s[36:39], s5 offen
L_near1:
    s_nop 1
L_ob_skip:
    v_max3_f32 v88, v48, v49, v50
    v_max3_f32 v89, v51, v52, v53
    v_max3_f32 v90, v54, v55, v56
    v_max3_f32 v91, v57, v58, v59
    v_max3_f32 v92, v60, v61, v62
    v_max3_f32 v93, v88, v89, v90
    v_max3_f32 v94, v91, v92, v63
    v_max_f32 v14, v93, v94
    v_mov_b32 v88, v14
    s_nop 1
    v_permlane32_swap_b32 v14, v88
    v_max_f32 v14, v14, v88
    v_mov_b32 v88, v14
    s_nop 1
    v_permlane16_swap_b32 v14, v88
    v_max_f32 v14, v14, v88
    v_mul_f32 v12, s54, v14
    s_barrier
    s_waitcnt vmcnt(5)
    s_add_u32 m0, s57, 8192
    s_add_u32 s53, s66, 786432
    buffer_load_dwordx4 v128, s[8:11], s53 offen offset:0 nt lds
    s_waitcnt vmcnt(5)
    buffer_load_dwordx4 v129, s[8:11], s53 offen offset:1024 nt lds
    s_waitcnt vmcnt(5)
    buffer_load_dwordx4 v130, s[8:11], s53 offen offset:2048 nt lds
    s_waitcnt vmcnt(5)
    buffer_load_dwordx4 v131, s[8:11], s53 offen offset:3072 nt lds
    v_fma_f32 v48, v48, s54, -v12
    v_fma_f32 v49, v49, s54, -v12
    v_fma_f32 v50, v50, s54, -v12
    v_fma_f32 v51, v51, s54, -v12
    v_fma_f32 v52, v52, s54, -v12
    v_fma_f32 v53, v53, s54, -v12
    v_fma_f32 v54, v54, s54, -v12
    v_fma_f32 v55, v55, s54, -v12
    v_exp_f32 v48, v48
    v_exp_f32 v49, v49
    v_exp_f32 v50, v50
    v_exp_f32 v51, v51
    v_exp_f32 v52, v52
    v_exp_f32 v53, v53
    v_exp_f32 v54, v54
    v_exp_f32 v55, v55
    v_add_f32 v88, v48, v49
    v_add_f32 v89, v50, v51
    v_add_f32 v90, v52, v53
    v_add_f32 v91, v54, v55
    v_add_f32 v92, v88, v89
    v_add_f32 v93, v90, v91
    v_add_f32 v13, v92, v93
    v_cvt_pk_bf16_f32 v64, v48, v49
    v_cvt_pk_bf16_f32 v65, v50, v51
    v_cvt_pk_bf16_f32 v66, v52, v53
    v_cvt_pk_bf16_f32 v67, v54, v55
    v_fma_f32 v56, v56, s54, -v12
    v_fma_f32 v57, v57, s54, -v12
    v_fma_f32 v58, v58, s54, -v12
    v_fma_f32 v59, v59, s54, -v12
    v_fma_f32 v60, v60, s54, -v12
    v_fma_f32 v61, v61, s54, -v12
    v_fma_f32 v62, v62, s54, -v12
    v_fma_f32 v63, v63, s54, -v12
    v_exp_f32 v56, v56
    v_exp_f32 v57, v57
    v_exp_f32 v58, v58
    v_exp_f32 v59, v59
    v_exp_f32 v60, v60
    v_exp_f32 v61, v61
    v_exp_f32 v62, v62
    v_exp_f32 v63, v63
    v_add_f32 v88, v56, v57
    v_add_f32 v89, v58, v59
    v_add_f32 v90, v60, v61
    v_add_f32 v91, v62, v63
    v_add_f32 v92, v88, v89
    v_add_f32 v93, v90, v91
    v_add_f32 v94, v92, v93
    v_add_f32 v13, v94, v13
    v_cvt_pk_bf16_f32 v68, v56, v57
    v_cvt_pk_bf16_f32 v69, v58, v59
    v_cvt_pk_bf16_f32 v70, v60, v61
    v_cvt_pk_bf16_f32 v71, v62, v63
    ds_read_b128 v[136:139], v132 offset:0
    ds_read_b128 v[140:143], v133 offset:0
    ds_read_b128 v[144:147], v134 offset:0
    ds_read_b128 v[148:151], v135 offset:0
    v_perm_b32 v80, v64, v64, v8
    v_perm_b32 v81, v64, v64, v9
    v_perm_b32 v82, v64, v64, v10
    v_perm_b32 v83, v64, v64, v11
    v_mfma_f32_16x16x16_bf16 v[72:75], v[80:81], a[0:1], 0
    v_mfma_f32_16x16x16_bf16 v[76:79], v[80:81], a[2:3], 0
    v_perm_b32 v84, v65, v65, v8
    v_perm_b32 v85, v65, v65, v9
    v_mfma_f32_16x16x16_bf16 v[72:75], v[82:83], a[4:5], v[72:75]
    v_mfma_f32_16x16x16_bf16 v[76:79], v[82:83], a[6:7], v[76:79]
    v_perm_b32 v86, v65, v65, v10
    v_perm_b32 v87, v65, v65, v11
    v_mfma_f32_16x16x16_bf16 v[72:75], v[84:85], a[8:9], v[72:75]
    v_mfma_f32_16x16x16_bf16 v[76:79], v[84:85], a[10:11], v[76:79]
    v_mfma_f32_16x16x16_bf16 v[72:75], v[86:87], a[12:13], v[72:75]
    v_mfma_f32_16x16x16_bf16 v[76:79], v[86:87], a[14:15], v[76:79]
    s_waitcnt lgkmcnt(0)
    v_mfma_f32_16x16x32_bf16 v[48:51], v[136:139], v[16:19], 0
    v_mfma_f32_16x16x32_bf16 v[48:51], v[140:143], v[20:23], v[48:51]
    v_mfma_f32_16x16x32_bf16 v[48:51], v[144:147], v[24:27], v[48:51]
    v_mfma_f32_16x16x32_bf16 v[48:51], v[148:151], v[28:31], v[48:51]
    s_waitcnt vmcnt(5)
    s_add_u32 m0, s57, 12288
    s_add_u32 s53, s66, 917504
    buffer_load_dwordx4 v128, s[8:11], s53 offen offset:0 nt lds
    s_waitcnt vmcnt(5)
    buffer_load_dwordx4 v129, s[8:11], s53 offen offset:1024 nt lds
    s_waitcnt vmcnt(5)
    buffer_load_dwordx4 v130, s[8:11], s53 offen offset:2048 nt lds
    s_cmp_eq_u32 s7, 0
    s_nop 0
    s_cbranch_scc1 L_mlb_skip
    v_mov_b32 v5, 2147483632
    v_cmp_gt_u32 vcc, 4, v0
    s_nop 1
    v_cndmask_b32 v4, v5, v2, vcc
    s_lshr_b32 s5, s24, 3
    s_lshl_b32 s5, s5, 8
    s_and_b32 s6, s24, 3
    s_lshl_b32 s6, s6, 6
    s_add_u32 s5, s5, s6
    s_and_b32 s6, s24, 4
    s_lshl_b32 s6, s6, 1
    s_add_u32 s5, s5, s6
    s_add_u32 s5, s5, 270336
    s_cmp_eq_u32 s55, 0
    s_cbranch_scc1 L_far2
    buffer_store_dwordx2 v[182:183], v4, s[36:39], s5 offen
L_near2:
    s_nop 1
L_mlb_skip:
    s_waitcnt vmcnt(5)
    buffer_load_dwordx4 v131, s[8:11], s53 offen offset:3072 nt lds
    ds_read_b128 v[152:155], v132 offset:4096
    ds_read_b128 v[156:159], v133 offset:4096
    ds_read_b128 v[160:163], v134 offset:4096
    ds_read_b128 v[164:167], v135 offset:4096
    v_perm_b32 v80, v66, v66, v8
    v_perm_b32 v81, v66, v66, v9
    v_perm_b32 v82, v66, v66, v10
    v_perm_b32 v83, v66, v66, v11
    v_mfma_f32_16x16x16_bf16 v[72:75], v[80:81], a[16:17], v[72:75]
    v_mfma_f32_16x16x16_bf16 v[76:79], v[80:81], a[18:19], v[76:79]
    v_perm_b32 v84, v67, v67, v8
    v_perm_b32 v85, v67, v67, v9
    v_mfma_f32_16x16x16_bf16 v[72:75], v[82:83], a[20:21], v[72:75]
    v_mfma_f32_16x16x16_bf16 v[76:79], v[82:83], a[22:23], v[76:79]
    v_perm_b32 v86, v67, v67, v10
    v_perm_b32 v87, v67, v67, v11
    v_mfma_f32_16x16x16_bf16 v[72:75], v[84:85], a[24:25], v[72:75]
    v_mfma_f32_16x16x16_bf16 v[76:79], v[84:85], a[26:27], v[76:79]
    v_mfma_f32_16x16x16_bf16 v[72:75], v[86:87], a[28:29], v[72:75]
    v_mfma_f32_16x16x16_bf16 v[76:79], v[86:87], a[30:31], v[76:79]
    s_waitcnt lgkmcnt(0)
    v_mfma_f32_16x16x32_bf16 v[52:55], v[152:155], v[16:19], 0
    v_mfma_f32_16x16x32_bf16 v[52:55], v[156:159], v[20:23], v[52:55]
    v_mfma_f32_16x16x32_bf16 v[52:55], v[160:163], v[24:27], v[52:55]
    v_mfma_f32_16x16x32_bf16 v[52:55], v[164:167], v[28:31], v[52:55]
    s_barrier
    s_waitcnt vmcnt(5)
    s_add_u32 m0, s57, 16384
    s_add_u32 s53, s66, 1048576
    buffer_load_dwordx4 v128, s[8:11], s53 offen offset:0 nt lds
    s_waitcnt vmcnt(5)
    buffer_load_dwordx4 v129, s[8:11], s53 offen offset:1024 nt lds
    s_waitcnt vmcnt(5)
    buffer_load_dwordx4 v130, s[8:11], s53 offen offset:2048 nt lds
    s_waitcnt vmcnt(5)
    buffer_load_dwordx4 v131, s[8:11], s53 offen offset:3072 nt lds
    ds_read_b128 v[136:139], v132 offset:8192
    ds_read_b128 v[140:143], v133 offset:8192
    ds_read_b128 v[144:147], v134 offset:8192
    ds_read_b128 v[148:151], v135 offset:8192
    v_perm_b32 v80, v68, v68, v8
    v_perm_b32 v81, v68, v68, v9
    v_perm_b32 v82, v68, v68, v10
    v_perm_b32 v83, v68, v68, v11
    v_mfma_f32_16x16x16_bf16 v[72:75], v[80:81], a[32:33], v[72:75]
    v_mfma_f32_16x16x16_bf16 v[76:79], v[80:81], a[34:35], v[76:79]
    v_perm_b32 v84, v69, v69, v8
    v_perm_b32 v85, v69, v69, v9
    v_mfma_f32_16x16x16_bf16 v[72:75], v[82:83], a[36:37], v[72:75]
    v_mfma_f32_16x16x16_bf16 v[76:79], v[82:83], a[38:39], v[76:79]
    v_perm_b32 v86, v69, v69, v10
    v_perm_b32 v87, v69, v69, v11
    v_mfma_f32_16x16x16_bf16 v[72:75], v[84:85], a[40:41], v[72:75]
    v_mfma_f32_16x16x16_bf16 v[76:79], v[84:85], a[42:43], v[76:79]
    v_mfma_f32_16x16x16_bf16 v[72:75], v[86:87], a[44:45], v[72:75]
    v_mfma_f32_16x16x16_bf16 v[76:79], v[86:87], a[46:47], v[76:79]
    s_waitcnt lgkmcnt(0)
    v_mfma_f32_16x16x32_bf16 v[56:59], v[136:139], v[16:19], 0
    v_mfma_f32_16x16x32_bf16 v[56:59], v[140:143], v[20:23], v[56:59]
    v_mfma_f32_16x16x32_bf16 v[56:59], v[144:147], v[24:27], v[56:59]
    v_mfma_f32_16x16x32_bf16 v[56:59], v[148:151], v[28:31], v[56:59]
    v_perm_b32 v80, v70, v70, v8
    v_perm_b32 v81, v70, v70, v9
    v_perm_b32 v82, v70, v70, v10
    v_perm_b32 v83, v70, v70, v11
    v_mfma_f32_16x16x16_bf16 v[72:75], v[80:81], a[48:49], v[72:75]
    v_mfma_f32_16x16x16_bf16 v[76:79], v[80:81], a[50:51], v[76:79]
    v_perm_b32 v84, v71, v71, v8
    v_perm_b32 v85, v71, v71, v9
    v_mfma_f32_16x16x16_bf16 v[72:75], v[82:83], a[52:53], v[72:75]
    v_mfma_f32_16x16x16_bf16 v[76:79], v[82:83], a[54:55], v[76:79]
    v_perm_b32 v86, v71, v71, v10
    v_perm_b32 v87, v71, v71, v11
    v_mfma_f32_16x16x16_bf16 v[72:75], v[84:85], a[56:57], v[72:75]
    v_mfma_f32_16x16x16_bf16 v[76:79], v[84:85], a[58:59], v[76:79]
    v_mfma_f32_16x16x16_bf16 v[72:75], v[86:87], a[60:61], v[72:75]
    v_mfma_f32_16x16x16_bf16 v[76:79], v[86:87], a[62:63], v[76:79]
    v_max3_f32 v88, v14, v48, v49
    v_max3_f32 v89, v50, v51, v52
    v_max3_f32 v90, v53, v54, v55
    v_max3_f32 v91, v56, v57, v58
    v_max3_f32 v92, v88, v89, v90
    v_max_f32 v93, v91, v59
    v_max_f32 v14, v92, v93
    v_mov_b32 v88, v14
    s_nop 1
    v_permlane32_swap_b32 v14, v88
    v_max_f32 v14, v14, v88
    v_mov_b32 v88, v14
    s_nop 1
    v_permlane16_swap_b32 v14, v88
    v_max_f32 v14, v14, v88
    v_mov_b32 v15, v12
    v_mul_f32 v12, s54, v14
    v_sub_f32 v88, v15, v12
    v_exp_f32 v88, v88
    s_nop 0
    v_mul_f32 v13, v13, v88
    v_mul_f32_dpp v72, v88, v72 quad_perm:[0,0,0,0] row_mask:0xf bank_mask:0xf
    v_mul_f32_dpp v73, v88, v73 quad_perm:[1,1,1,1] row_mask:0xf bank_mask:0xf
    v_mul_f32_dpp v74, v88, v74 quad_perm:[2,2,2,2] row_mask:0xf bank_mask:0xf
    v_mul_f32_dpp v75, v88, v75 quad_perm:[3,3,3,3] row_mask:0xf bank_mask:0xf
    v_mul_f32_dpp v76, v88, v76 quad_perm:[0,0,0,0] row_mask:0xf bank_mask:0xf
    v_mul_f32_dpp v77, v88, v77 quad_perm:[1,1,1,1] row_mask:0xf bank_mask:0xf
    v_mul_f32_dpp v78, v88, v78 quad_perm:[2,2,2,2] row_mask:0xf bank_mask:0xf
    v_mul_f32_dpp v79, v88, v79 quad_perm:[3,3,3,3] row_mask:0xf bank_mask:0xf
    v_fma_f32 v48, v48, s54, -v12
    v_fma_f32 v49, v49, s54, -v12
    v_fma_f32 v50, v50, s54, -v12
    v_fma_f32 v51, v51, s54, -v12
    v_fma_f32 v52, v52, s54, -v12
    v_fma_f32 v53, v53, s54, -v12
    v_fma_f32 v54, v54, s54, -v12
    v_fma_f32 v55, v55, s54, -v12
    v_exp_f32 v48, v48
    v_exp_f32 v49, v49
    v_exp_f32 v50, v50
    v_exp_f32 v51, v51
    v_exp_f32 v52, v52
    v_exp_f32 v53, v53
    v_exp_f32 v54, v54
    v_exp_f32 v55, v55
    v_add_f32 v88, v48, v49
    v_add_f32 v89, v50, v51
    v_add_f32 v90, v52, v53
    v_add_f32 v91, v54, v55
    v_add_f32 v92, v88, v89
    v_add_f32 v93, v90, v91
    v_add_f32 v94, v92, v93
    v_add_f32 v13, v94, v13
    v_cvt_pk_bf16_f32 v64, v48, v49
    v_cvt_pk_bf16_f32 v65, v50, v51
    v_cvt_pk_bf16_f32 v66, v52, v53
    v_cvt_pk_bf16_f32 v67, v54, v55
    s_waitcnt vmcnt(5)
    s_add_u32 m0, s57, 20480
    s_add_u32 s53, s66, 1179648
    buffer_load_dwordx4 v128, s[8:11], s53 offen offset:0 nt lds
    s_waitcnt vmcnt(5)
    buffer_load_dwordx4 v129, s[8:11], s53 offen offset:1024 nt lds
    s_waitcnt vmcnt(5)
    buffer_load_dwordx4 v130, s[8:11], s53 offen offset:2048 nt lds
    s_waitcnt vmcnt(5)
    buffer_load_dwordx4 v131, s[8:11], s53 offen offset:3072 nt lds
    v_fma_f32 v56, v56, s54, -v12
    v_fma_f32 v57, v57, s54, -v12
    v_fma_f32 v58, v58, s54, -v12
    v_fma_f32 v59, v59, s54, -v12
    v_exp_f32 v56, v56
    v_exp_f32 v57, v57
    v_exp_f32 v58, v58
    v_exp_f32 v59, v59
    v_add_f32 v88, v56, v57
    v_add_f32 v89, v58, v59
    v_add_f32 v90, v88, v89
    v_add_f32 v13, v90, v13
    v_cvt_pk_bf16_f32 v68, v56, v57
    v_cvt_pk_bf16_f32 v69, v58, v59
    ds_read_b128 v[136:139], v132 offset:12288
    ds_read_b128 v[140:143], v133 offset:12288
    ds_read_b128 v[144:147], v134 offset:12288
    ds_read_b128 v[148:151], v135 offset:12288
    v_perm_b32 v80, v64, v64, v8
    v_perm_b32 v81, v64, v64, v9
    v_perm_b32 v82, v64, v64, v10
    v_perm_b32 v83, v64, v64, v11
    v_mfma_f32_16x16x16_bf16 v[72:75], v[80:81], a[64:65], v[72:75]
    v_mfma_f32_16x16x16_bf16 v[76:79], v[80:81], a[66:67], v[76:79]
    v_perm_b32 v84, v65, v65, v8
    v_perm_b32 v85, v65, v65, v9
    v_mfma_f32_16x16x16_bf16 v[72:75], v[82:83], a[68:69], v[72:75]
    v_mfma_f32_16x16x16_bf16 v[76:79], v[82:83], a[70:71], v[76:79]
    v_perm_b32 v86, v65, v65, v10
    v_perm_b32 v87, v65, v65, v11
    v_mfma_f32_16x16x16_bf16 v[72:75], v[84:85], a[72:73], v[72:75]
    v_mfma_f32_16x16x16_bf16 v[76:79], v[84:85], a[74:75], v[76:79]
    v_mfma_f32_16x16x16_bf16 v[72:75], v[86:87], a[76:77], v[72:75]
    v_mfma_f32_16x16x16_bf16 v[76:79], v[86:87], a[78:79], v[76:79]
    s_waitcnt lgkmcnt(0)
    v_mfma_f32_16x16x32_bf16 v[48:51], v[136:139], v[16:19], 0
    v_mfma_f32_16x16x32_bf16 v[48:51], v[140:143], v[20:23], v[48:51]
    v_mfma_f32_16x16x32_bf16 v[48:51], v[144:147], v[24:27], v[48:51]
    v_mfma_f32_16x16x32_bf16 v[48:51], v[148:151], v[28:31], v[48:51]
    s_barrier
    s_waitcnt vmcnt(5)
    s_add_u32 m0, s57, 24576
    s_add_u32 s53, s66, 1310720
    buffer_load_dwordx4 v128, s[8:11], s53 offen offset:0 nt lds
    s_waitcnt vmcnt(5)
    buffer_load_dwordx4 v129, s[8:11], s53 offen offset:1024 nt lds
    s_waitcnt vmcnt(5)
    buffer_load_dwordx4 v130, s[8:11], s53 offen offset:2048 nt lds
    s_waitcnt vmcnt(5)
    buffer_load_dwordx4 v131, s[8:11], s53 offen offset:3072 nt lds
    ds_read_b128 v[152:155], v132 offset:16384
    ds_read_b128 v[156:159], v133 offset:16384
    ds_read_b128 v[160:163], v134 offset:16384
    ds_read_b128 v[164:167], v135 offset:16384
    v_perm_b32 v80, v66, v66, v8
    v_perm_b32 v81, v66, v66, v9
    v_perm_b32 v82, v66, v66, v10
    v_perm_b32 v83, v66, v66, v11
    v_mfma_f32_16x16x16_bf16 v[72:75], v[80:81], a[80:81], v[72:75]
    v_mfma_f32_16x16x16_bf16 v[76:79], v[80:81], a[82:83], v[76:79]
    v_perm_b32 v84, v67, v67, v8
    v_perm_b32 v85, v67, v67, v9
    v_mfma_f32_16x16x16_bf16 v[72:75], v[82:83], a[84:85], v[72:75]
    v_mfma_f32_16x16x16_bf16 v[76:79], v[82:83], a[86:87], v[76:79]
    v_perm_b32 v86, v67, v67, v10
    v_perm_b32 v87, v67, v67, v11
    v_mfma_f32_16x16x16_bf16 v[72:75], v[84:85], a[88:89], v[72:75]
    v_mfma_f32_16x16x16_bf16 v[76:79], v[84:85], a[90:91], v[76:79]
    v_mfma_f32_16x16x16_bf16 v[72:75], v[86:87], a[92:93], v[72:75]
    v_mfma_f32_16x16x16_bf16 v[76:79], v[86:87], a[94:95], v[76:79]
    s_waitcnt lgkmcnt(0)
    v_mfma_f32_16x16x32_bf16 v[52:55], v[152:155], v[16:19], 0
    v_mfma_f32_16x16x32_bf16 v[52:55], v[156:159], v[20:23], v[52:55]
    v_mfma_f32_16x16x32_bf16 v[52:55], v[160:163], v[24:27], v[52:55]
    v_mfma_f32_16x16x32_bf16 v[52:55], v[164:167], v[28:31], v[52:55]
    s_waitcnt vmcnt(5)
    s_add_u32 m0, s57, 28672
    s_add_u32 s53, s66, 1441792
    buffer_load_dwordx4 v128, s[8:11], s53 offen offset:0 nt lds
    s_waitcnt vmcnt(5)
    buffer_load_dwordx4 v129, s[8:11], s53 offen offset:1024 nt lds
    s_waitcnt vmcnt(5)
    buffer_load_dwordx4 v130, s[8:11], s53 offen offset:2048 nt lds
    s_waitcnt vmcnt(5)
    buffer_load_dwordx4 v131, s[8:11], s53 offen offset:3072 nt lds
    ds_read_b128 v[136:139], v132 offset:20480
    ds_read_b128 v[140:143], v133 offset:20480
    ds_read_b128 v[144:147], v134 offset:20480
    ds_read_b128 v[148:151], v135 offset:20480
    v_perm_b32 v80, v68, v68, v8
    v_perm_b32 v81, v68, v68, v9
    v_perm_b32 v82, v68, v68, v10
    v_perm_b32 v83, v68, v68, v11
    v_mfma_f32_16x16x16_bf16 v[72:75], v[80:81], a[96:97], v[72:75]
    v_mfma_f32_16x16x16_bf16 v[76:79], v[80:81], a[98:99], v[76:79]
    v_perm_b32 v84, v69, v69, v8
    v_perm_b32 v85, v69, v69, v9
    v_mfma_f32_16x16x16_bf16 v[72:75], v[82:83], a[100:101], v[72:75]
    v_mfma_f32_16x16x16_bf16 v[76:79], v[82:83], a[102:103], v[76:79]
    v_perm_b32 v86, v69, v69, v10
    v_perm_b32 v87, v69, v69, v11
    v_mfma_f32_16x16x16_bf16 v[72:75], v[84:85], a[104:105], v[72:75]
    v_mfma_f32_16x16x16_bf16 v[76:79], v[84:85], a[106:107], v[76:79]
    v_mfma_f32_16x16x16_bf16 v[72:75], v[86:87], a[108:109], v[72:75]
    v_mfma_f32_16x16x16_bf16 v[76:79], v[86:87], a[110:111], v[76:79]
    s_waitcnt lgkmcnt(0)
    v_mfma_f32_16x16x32_bf16 v[56:59], v[136:139], v[16:19], 0
    v_mfma_f32_16x16x32_bf16 v[56:59], v[140:143], v[20:23], v[56:59]
    v_mfma_f32_16x16x32_bf16 v[56:59], v[144:147], v[24:27], v[56:59]
    v_mfma_f32_16x16x32_bf16 v[56:59], v[148:151], v[28:31], v[56:59]
    v_max3_f32 v88, v14, v48, v49
    v_max3_f32 v89, v50, v51, v52
    v_max3_f32 v90, v53, v54, v55
    s_nop 4
    v_max3_f32 v91, v56, v57, v58
    v_max3_f32 v92, v88, v89, v90
    v_max_f32 v93, v91, v59
    v_max_f32 v14, v92, v93
    v_mov_b32 v88, v14
    s_nop 1
    v_permlane32_swap_b32 v14, v88
    v_max_f32 v14, v14, v88
    v_mov_b32 v88, v14
    s_nop 1
    v_permlane16_swap_b32 v14, v88
    v_max_f32 v14, v14, v88
    v_mov_b32 v15, v12
    v_mul_f32 v12, s54, v14
    v_sub_f32 v88, v15, v12
    v_exp_f32 v88, v88
    s_nop 0
    v_mul_f32 v13, v13, v88
    v_mul_f32_dpp v72, v88, v72 quad_perm:[0,0,0,0] row_mask:0xf bank_mask:0xf
    v_mul_f32_dpp v73, v88, v73 quad_perm:[1,1,1,1] row_mask:0xf bank_mask:0xf
    v_mul_f32_dpp v74, v88, v74 quad_perm:[2,2,2,2] row_mask:0xf bank_mask:0xf
    v_mul_f32_dpp v75, v88, v75 quad_perm:[3,3,3,3] row_mask:0xf bank_mask:0xf
    v_mul_f32_dpp v76, v88, v76 quad_perm:[0,0,0,0] row_mask:0xf bank_mask:0xf
    v_mul_f32_dpp v77, v88, v77 quad_perm:[1,1,1,1] row_mask:0xf bank_mask:0xf
    v_mul_f32_dpp v78, v88, v78 quad_perm:[2,2,2,2] row_mask:0xf bank_mask:0xf
    v_mul_f32_dpp v79, v88, v79 quad_perm:[3,3,3,3] row_mask:0xf bank_mask:0xf
    v_fma_f32 v48, v48, s54, -v12
    v_fma_f32 v49, v49, s54, -v12
    v_fma_f32 v50, v50, s54, -v12
    v_fma_f32 v51, v51, s54, -v12
    v_fma_f32 v52, v52, s54, -v12
    v_fma_f32 v53, v53, s54, -v12
    v_fma_f32 v54, v54, s54, -v12
    v_fma_f32 v55, v55, s54, -v12
    v_exp_f32 v48, v48
    v_exp_f32 v49, v49
    v_exp_f32 v50, v50
    v_exp_f32 v51, v51
    v_exp_f32 v52, v52
    v_exp_f32 v53, v53
    v_exp_f32 v54, v54
    v_exp_f32 v55, v55
    v_add_f32 v88, v48, v49
    v_add_f32 v89, v50, v51
    v_add_f32 v90, v52, v53
    v_add_f32 v91, v54, v55
    v_add_f32 v92, v88, v89
    v_add_f32 v93, v90, v91
    v_add_f32 v94, v92, v93
    v_add_f32 v13, v94, v13
    v_cvt_pk_bf16_f32 v64, v48, v49
    v_cvt_pk_bf16_f32 v65, v50, v51
    v_cvt_pk_bf16_f32 v66, v52, v53
    v_cvt_pk_bf16_f32 v67, v54, v55
    v_fma_f32 v56, v56, s54, -v12
    v_fma_f32 v57, v57, s54, -v12
    v_fma_f32 v58, v58, s54, -v12
    v_fma_f32 v59, v59, s54, -v12
    v_exp_f32 v56, v56
    v_exp_f32 v57, v57
    v_exp_f32 v58, v58
    v_exp_f32 v59, v59
    v_add_f32 v88, v56, v57
    v_add_f32 v89, v58, v59
    v_add_f32 v90, v88, v89
    v_add_f32 v13, v90, v13
    v_cvt_pk_bf16_f32 v68, v56, v57
    v_cvt_pk_bf16_f32 v69, v58, v59
    s_barrier
    s_waitcnt vmcnt(5)
    s_add_u32 m0, s57, 0
    s_add_u32 s53, s66, 1572864
    buffer_load_dwordx4 v128, s[8:11], s53 offen offset:0 nt lds
    s_waitcnt vmcnt(5)
    buffer_load_dwordx4 v129, s[8:11], s53 offen offset:1024 nt lds
    s_waitcnt vmcnt(5)
    buffer_load_dwordx4 v130, s[8:11], s53 offen offset:2048 nt lds
    s_andn2_b32 s6, s99, 1
    s_xor_b32 s5, s24, s6
    s_and_b32 s5, s5, 7
    s_cbranch_scc1 L_c1_skip
    s_lshr_b32 s5, s24, 3
    s_lshl_b32 s5, s5, 8
    s_add_u32 s5, s5, 270336
    v_lshlrev_b32 v4, 2, v0
    v_and_b32 v4, 0xf0, v4
    buffer_load_dwordx4 v[32:35], v4, s[36:39], s5 offen sc1
    s_nop 1
L_c1_skip:
    s_waitcnt vmcnt(5)
    buffer_load_dwordx4 v131, s[8:11], s53 offen offset:3072 nt lds
    ds_read_b128 v[136:139], v132 offset:24576
    ds_read_b128 v[140:143], v133 offset:24576
    ds_read_b128 v[144:147], v134 offset:24576
    ds_read_b128 v[148:151], v135 offset:24576
    v_perm_b32 v80, v64, v64, v8
    v_perm_b32 v81, v64, v64, v9
    v_perm_b32 v82, v64, v64, v10
    v_perm_b32 v83, v64, v64, v11
    v_mfma_f32_16x16x16_bf16 v[72:75], v[80:81], a[112:113], v[72:75]
    v_mfma_f32_16x16x16_bf16 v[76:79], v[80:81], a[114:115], v[76:79]
    v_perm_b32 v84, v65, v65, v8
    v_perm_b32 v85, v65, v65, v9
    v_mfma_f32_16x16x16_bf16 v[72:75], v[82:83], a[116:117], v[72:75]
    v_mfma_f32_16x16x16_bf16 v[76:79], v[82:83], a[118:119], v[76:79]
    v_perm_b32 v86, v65, v65, v10
    v_perm_b32 v87, v65, v65, v11
    v_mfma_f32_16x16x16_bf16 v[72:75], v[84:85], a[120:121], v[72:75]
    v_mfma_f32_16x16x16_bf16 v[76:79], v[84:85], a[122:123], v[76:79]
    v_mfma_f32_16x16x16_bf16 v[72:75], v[86:87], a[124:125], v[72:75]
    v_mfma_f32_16x16x16_bf16 v[76:79], v[86:87], a[126:127], v[76:79]
    s_waitcnt lgkmcnt(0)
    v_mfma_f32_16x16x32_bf16 v[48:51], v[136:139], v[16:19], 0
    v_mfma_f32_16x16x32_bf16 v[48:51], v[140:143], v[20:23], v[48:51]
    v_mfma_f32_16x16x32_bf16 v[48:51], v[144:147], v[24:27], v[48:51]
    v_mfma_f32_16x16x32_bf16 v[48:51], v[148:151], v[28:31], v[48:51]
    s_waitcnt vmcnt(5)
    s_add_u32 s53, s66, 1310720
    buffer_load_dwordx4 a[160:163], v2, s[12:15], s53 offen offset:0 nt
    s_waitcnt vmcnt(5)
    buffer_load_dwordx4 a[164:167], v2, s[12:15], s53 offen offset:1024 nt
    s_waitcnt vmcnt(5)
    buffer_load_dwordx4 a[168:171], v2, s[12:15], s53 offen offset:2048 nt
    s_waitcnt vmcnt(5)
    buffer_load_dwordx4 a[172:175], v2, s[12:15], s53 offen offset:3072 nt
    ds_read_b128 v[152:155], v132 offset:28672
    ds_read_b128 v[156:159], v133 offset:28672
    ds_read_b128 v[160:163], v134 offset:28672
    ds_read_b128 v[164:167], v135 offset:28672
    v_perm_b32 v80, v66, v66, v8
    v_perm_b32 v81, v66, v66, v9
    v_perm_b32 v82, v66, v66, v10
    v_perm_b32 v83, v66, v66, v11
    v_mfma_f32_16x16x16_bf16 v[72:75], v[80:81], a[128:129], v[72:75]
    v_mfma_f32_16x16x16_bf16 v[76:79], v[80:81], a[130:131], v[76:79]
    v_perm_b32 v84, v67, v67, v8
    v_perm_b32 v85, v67, v67, v9
    v_mfma_f32_16x16x16_bf16 v[72:75], v[82:83], a[132:133], v[72:75]
    v_mfma_f32_16x16x16_bf16 v[76:79], v[82:83], a[134:135], v[76:79]
    v_perm_b32 v86, v67, v67, v10
    v_perm_b32 v87, v67, v67, v11
    v_mfma_f32_16x16x16_bf16 v[72:75], v[84:85], a[136:137], v[72:75]
    v_mfma_f32_16x16x16_bf16 v[76:79], v[84:85], a[138:139], v[76:79]
    v_mfma_f32_16x16x16_bf16 v[72:75], v[86:87], a[140:141], v[72:75]
    v_mfma_f32_16x16x16_bf16 v[76:79], v[86:87], a[142:143], v[76:79]
    s_waitcnt lgkmcnt(0)
    v_mfma_f32_16x16x32_bf16 v[52:55], v[152:155], v[16:19], 0
    v_mfma_f32_16x16x32_bf16 v[52:55], v[156:159], v[20:23], v[52:55]
    v_mfma_f32_16x16x32_bf16 v[52:55], v[160:163], v[24:27], v[52:55]
    v_mfma_f32_16x16x32_bf16 v[52:55], v[164:167], v[28:31], v[52:55]
    s_barrier
    s_waitcnt vmcnt(5)
    s_add_u32 s53, s66, 1441792
    buffer_load_dwordx4 a[176:179], v2, s[12:15], s53 offen offset:0 nt
    s_waitcnt vmcnt(5)
    buffer_load_dwordx4 a[180:183], v2, s[12:15], s53 offen offset:1024 nt
    s_andn2_b32 s6, s99, 1
    s_xor_b32 s5, s24, s6
    s_and_b32 s5, s5, 7
    s_cbranch_scc1 L_c2_skip
    s_mov_b32 s56, 100000
L_c2_chk:
    v_max3_u32 v3, v32, v33, v34
    v_max_u32 v3, v3, v35
    v_cmp_eq_u32 vcc, -1, v3
    s_nop 0
    s_cbranch_vccz L_c2_ok
    s_lshr_b32 s5, s24, 3
    s_lshl_b32 s5, s5, 8
    s_add_u32 s5, s5, 270336
    v_lshlrev_b32 v4, 2, v0
    v_and_b32 v4, 0xf0, v4
    buffer_load_dwordx4 v[32:35], v4, s[36:39], s5 offen sc1
    s_sub_u32 s56, s56, 1
    s_waitcnt vmcnt(0)
    s_cbranch_scc0 L_c2_chk
L_c2_ok:
    s_andn2_b32 s5, s24, 7
    s_lshr_b32 s6, s5, 7
    s_lshl_b32 s6, s6, 17
    s_and_b32 s5, s5, 127
    s_lshl_b32 s5, s5, 8
    s_add_u32 s5, s5, s6
    s_lshl_b32 s6, s48, 15
    s_add_u32 s5, s5, s6
    s_add_u32 s5, s5, 2097152
    buffer_load_dwordx4 v[40:43], v2, s[36:39], s5 offen offset:0 sc1
    buffer_load_dwordx4 v[44:47], v2, s[36:39], s5 offen offset:1024 sc1
    v_max_f32 v88, v32, v34
    v_mov_b32 v89, v88
    s_nop 1
    v_permlane32_swap_b32 v88, v89
    v_max_f32 v88, v88, v89
    v_mov_b32 v89, v88
    s_nop 1
    v_permlane16_swap_b32 v88, v89
    v_max_f32 v88, v88, v89
    v_sub_f32 v32, v32, v88
    v_sub_f32 v34, v34, v88
    v_exp_f32 v32, v32
    v_exp_f32 v34, v34
    v_mul_f32 v88, v32, v33
    v_fmac_f32 v88, v34, v35
    v_mov_b32 v89, v88
    s_nop 1
    v_permlane32_swap_b32 v88, v89
    v_add_f32 v88, v88, v89
    v_mov_b32 v89, v88
    s_nop 1
    v_permlane16_swap_b32 v88, v89
    v_add_f32 v88, v88, v89
    v_rcp_f32 v88, v88
    s_nop 0
    v_mul_f32 v32, v32, v88
    v_mul_f32 v34, v34, v88
    v_cvt_pk_bf16_f32 v32, v32, v34
    v_perm_b32 v36, v32, v32, v8
    v_perm_b32 v37, v32, v32, v9
    v_perm_b32 v38, v32, v32, v10
    v_perm_b32 v39, v32, v32, v11
    s_nop 1
L_c2_skip:
    s_waitcnt vmcnt(5)
    buffer_load_dwordx4 a[184:187], v2, s[12:15], s53 offen offset:2048 nt
    s_waitcnt vmcnt(5)
    buffer_load_dwordx4 a[188:191], v2, s[12:15], s53 offen offset:3072 nt
    ds_read_b128 v[136:139], v132 offset:0
    ds_read_b128 v[140:143], v133 offset:0
    ds_read_b128 v[144:147], v134 offset:0
    ds_read_b128 v[148:151], v135 offset:0
    v_perm_b32 v80, v68, v68, v8
    v_perm_b32 v81, v68, v68, v9
    v_perm_b32 v82, v68, v68, v10
    v_perm_b32 v83, v68, v68, v11
    v_mfma_f32_16x16x16_bf16 v[72:75], v[80:81], a[144:145], v[72:75]
    v_mfma_f32_16x16x16_bf16 v[76:79], v[80:81], a[146:147], v[76:79]
    v_perm_b32 v84, v69, v69, v8
    v_perm_b32 v85, v69, v69, v9
    v_mfma_f32_16x16x16_bf16 v[72:75], v[82:83], a[148:149], v[72:75]
    v_mfma_f32_16x16x16_bf16 v[76:79], v[82:83], a[150:151], v[76:79]
    v_perm_b32 v86, v69, v69, v10
    v_perm_b32 v87, v69, v69, v11
    v_mfma_f32_16x16x16_bf16 v[72:75], v[84:85], a[152:153], v[72:75]
    v_mfma_f32_16x16x16_bf16 v[76:79], v[84:85], a[154:155], v[76:79]
    v_mfma_f32_16x16x16_bf16 v[72:75], v[86:87], a[156:157], v[72:75]
    v_mfma_f32_16x16x16_bf16 v[76:79], v[86:87], a[158:159], v[76:79]
    s_waitcnt lgkmcnt(0)
    v_mfma_f32_16x16x32_bf16 v[56:59], v[136:139], v[16:19], 0
    v_mfma_f32_16x16x32_bf16 v[56:59], v[140:143], v[20:23], v[56:59]
    v_mfma_f32_16x16x32_bf16 v[56:59], v[144:147], v[24:27], v[56:59]
    v_mfma_f32_16x16x32_bf16 v[56:59], v[148:151], v[28:31], v[56:59]
    v_max3_f32 v88, v14, v48, v49
    v_max3_f32 v89, v50, v51, v52
    v_max3_f32 v90, v53, v54, v55
    s_nop 4
    v_max3_f32 v91, v56, v57, v58
    v_max3_f32 v92, v88, v89, v90
    v_max_f32 v93, v91, v59
    v_max_f32 v14, v92, v93
    v_mov_b32 v88, v14
    s_nop 1
    v_permlane32_swap_b32 v14, v88
    v_max_f32 v14, v14, v88
    v_mov_b32 v88, v14
    s_nop 1
    v_permlane16_swap_b32 v14, v88
    v_max_f32 v14, v14, v88
    v_mov_b32 v15, v12
    v_mul_f32 v12, s54, v14
    v_sub_f32 v88, v15, v12
    v_exp_f32 v88, v88
    s_nop 0
    v_mul_f32 v13, v13, v88
    v_mul_f32_dpp v72, v88, v72 quad_perm:[0,0,0,0] row_mask:0xf bank_mask:0xf
    v_mul_f32_dpp v73, v88, v73 quad_perm:[1,1,1,1] row_mask:0xf bank_mask:0xf
    v_mul_f32_dpp v74, v88, v74 quad_perm:[2,2,2,2] row_mask:0xf bank_mask:0xf
    v_mul_f32_dpp v75, v88, v75 quad_perm:[3,3,3,3] row_mask:0xf bank_mask:0xf
    v_mul_f32_dpp v76, v88, v76 quad_perm:[0,0,0,0] row_mask:0xf bank_mask:0xf
    v_mul_f32_dpp v77, v88, v77 quad_perm:[1,1,1,1] row_mask:0xf bank_mask:0xf
    v_mul_f32_dpp v78, v88, v78 quad_perm:[2,2,2,2] row_mask:0xf bank_mask:0xf
    v_mul_f32_dpp v79, v88, v79 quad_perm:[3,3,3,3] row_mask:0xf bank_mask:0xf
    v_fma_f32 v48, v48, s54, -v12
    v_fma_f32 v49, v49, s54, -v12
    v_fma_f32 v50, v50, s54, -v12
    v_fma_f32 v51, v51, s54, -v12
    v_fma_f32 v52, v52, s54, -v12
    v_fma_f32 v53, v53, s54, -v12
    v_fma_f32 v54, v54, s54, -v12
    v_fma_f32 v55, v55, s54, -v12
    v_exp_f32 v48, v48
    v_exp_f32 v49, v49
    v_exp_f32 v50, v50
    v_exp_f32 v51, v51
    v_exp_f32 v52, v52
    v_exp_f32 v53, v53
    v_exp_f32 v54, v54
    v_exp_f32 v55, v55
    v_add_f32 v88, v48, v49
    v_add_f32 v89, v50, v51
    v_add_f32 v90, v52, v53
    v_add_f32 v91, v54, v55
    v_add_f32 v92, v88, v89
    v_add_f32 v93, v90, v91
    v_add_f32 v94, v92, v93
    v_add_f32 v13, v94, v13
    v_cvt_pk_bf16_f32 v64, v48, v49
    v_cvt_pk_bf16_f32 v65, v50, v51
    v_cvt_pk_bf16_f32 v66, v52, v53
    v_cvt_pk_bf16_f32 v67, v54, v55
    v_fma_f32 v56, v56, s54, -v12
    v_fma_f32 v57, v57, s54, -v12
    v_fma_f32 v58, v58, s54, -v12
    v_fma_f32 v59, v59, s54, -v12
    v_exp_f32 v56, v56
    v_exp_f32 v57, v57
    v_exp_f32 v58, v58
    v_exp_f32 v59, v59
    v_add_f32 v88, v56, v57
    v_add_f32 v89, v58, v59
    v_add_f32 v90, v88, v89
    v_add_f32 v13, v90, v13
    v_cvt_pk_bf16_f32 v68, v56, v57
    v_cvt_pk_bf16_f32 v69, v58, v59
    s_waitcnt vmcnt(5)
    s_lshl_b32 s51, s99, 2
    s_add_u32 s51, s51, s48
    s_lshl_b32 s51, s51, 12
    s_add_u32 s51, s51, 1703936
    buffer_load_dwordx4 v[192:195], v1, s[8:11], s51 offen offset:0 nt
    s_waitcnt vmcnt(5)
    buffer_load_dwordx4 v[196:199], v1, s[8:11], s51 offen offset:64 nt
    s_waitcnt vmcnt(5)
    buffer_load_dwordx4 v[200:203], v1, s[8:11], s51 offen offset:128 nt
    s_waitcnt vmcnt(5)
    buffer_load_dwordx4 v[204:207], v1, s[8:11], s51 offen offset:192 nt
    s_mov_b32 s67, 1
    s_atomic_add s67, s[36:37], s3 glc
    v_perm_b32 v80, v64, v64, v8
    v_perm_b32 v81, v64, v64, v9
    v_perm_b32 v82, v64, v64, v10
    v_perm_b32 v83, v64, v64, v11
    v_mfma_f32_16x16x16_bf16 v[72:75], v[80:81], a[160:161], v[72:75]
    v_mfma_f32_16x16x16_bf16 v[76:79], v[80:81], a[162:163], v[76:79]
    v_perm_b32 v84, v65, v65, v8
    v_perm_b32 v85, v65, v65, v9
    v_mfma_f32_16x16x16_bf16 v[72:75], v[82:83], a[164:165], v[72:75]
    v_mfma_f32_16x16x16_bf16 v[76:79], v[82:83], a[166:167], v[76:79]
    v_perm_b32 v86, v65, v65, v10
    v_perm_b32 v87, v65, v65, v11
    v_mfma_f32_16x16x16_bf16 v[72:75], v[84:85], a[168:169], v[72:75]
    v_mfma_f32_16x16x16_bf16 v[76:79], v[84:85], a[170:171], v[76:79]
    v_mfma_f32_16x16x16_bf16 v[72:75], v[86:87], a[172:173], v[72:75]
    v_mfma_f32_16x16x16_bf16 v[76:79], v[86:87], a[174:175], v[76:79]
    s_barrier
    s_waitcnt vmcnt(5)
    s_add_u32 s53, s66, 1572864
    buffer_load_dwordx4 a[224:227], v2, s[12:15], s53 offen offset:0 nt
    s_andn2_b32 s6, s99, 1
    s_xor_b32 s5, s24, s6
    s_and_b32 s5, s5, 7
    s_nop 0
    s_cbranch_scc1 L_c3_skip
    v_mfma_f32_16x16x16_bf16 v[88:91], v[36:37], v[40:41], 0
    v_mfma_f32_16x16x16_bf16 v[92:95], v[36:37], v[42:43], 0
    v_mfma_f32_16x16x16_bf16 v[88:91], v[38:39], v[44:45], v[88:91]
    v_mfma_f32_16x16x16_bf16 v[92:95], v[38:39], v[46:47], v[92:95]
    s_andn2_b32 s5, s24, 7
    s_lshr_b32 s6, s5, 7
    s_lshl_b32 s6, s6, 17
    s_and_b32 s5, s5, 127
    s_lshl_b32 s5, s5, 8
    s_add_u32 s5, s5, s6
    s_lshl_b32 s6, s48, 15
    s_add_u32 s5, s5, s6
    s_add_u32 s5, s5, 2621440
    v_lshl_add_u32 v4, v123, 24, v124
    v_cvt_pk_bf16_f32 v32, v88, v92
    v_mov_b32 v34, v32
    s_nop 1
    v_permlane32_swap_b32 v32, v34
    v_mov_b32 v33, v32
    v_mov_b32 v35, v34
    s_nop 0
    v_permlane16_swap_b32 v32, v33
    v_permlane16_swap_b32 v34, v35
    buffer_store_dwordx4 v[32:35], v4, s[36:39], s5 offen sc1
    s_nop 1
L_c3_skip:
    s_waitcnt vmcnt(5)
    buffer_load_dwordx4 a[228:231], v2, s[12:15], s53 offen offset:1024 nt
    s_waitcnt vmcnt(5)
    buffer_load_dwordx4 a[232:235], v2, s[12:15], s53 offen offset:2048 nt
    s_waitcnt vmcnt(5)
    buffer_load_dwordx4 a[236:239], v2, s[12:15], s53 offen offset:3072 nt
    v_perm_b32 v80, v66, v66, v8
    v_perm_b32 v81, v66, v66, v9
    v_perm_b32 v82, v66, v66, v10
    v_perm_b32 v83, v66, v66, v11
    v_mfma_f32_16x16x16_bf16 v[72:75], v[80:81], a[176:177], v[72:75]
    v_mfma_f32_16x16x16_bf16 v[76:79], v[80:81], a[178:179], v[76:79]
    v_perm_b32 v84, v67, v67, v8
    v_perm_b32 v85, v67, v67, v9
    v_mfma_f32_16x16x16_bf16 v[72:75], v[82:83], a[180:181], v[72:75]
    v_mfma_f32_16x16x16_bf16 v[76:79], v[82:83], a[182:183], v[76:79]
    v_perm_b32 v86, v67, v67, v10
    v_perm_b32 v87, v67, v67, v11
    v_mfma_f32_16x16x16_bf16 v[72:75], v[84:85], a[184:185], v[72:75]
    v_mfma_f32_16x16x16_bf16 v[76:79], v[84:85], a[186:187], v[76:79]
    v_mfma_f32_16x16x16_bf16 v[72:75], v[86:87], a[188:189], v[72:75]
    v_mfma_f32_16x16x16_bf16 v[76:79], v[86:87], a[190:191], v[76:79]
    v_mov_b32 v170, 1.0
    s_nop 6
L_it1:
    s_waitcnt lgkmcnt(0)
    s_add_u32 s52, s67, 33
    s_cmp_ge_u32 s52, 96
    s_cbranch_scc1 L_exit0
    s_lshl_b32 s52, s52, 12
    s_add_u32 s52, s52, 1703936
    s_waitcnt vmcnt(7)
    buffer_load_dwordx4 v[208:211], v1, s[8:11], s52 offen offset:0 nt
    s_waitcnt vmcnt(7)
    buffer_load_dwordx4 v[212:215], v1, s[8:11], s52 offen offset:64 nt
    s_waitcnt vmcnt(7)
    buffer_load_dwordx4 v[216:219], v1, s[8:11], s52 offen offset:128 nt
    s_waitcnt vmcnt(7)
    buffer_load_dwordx4 v[220:223], v1, s[8:11], s52 offen offset:192 nt
    s_mov_b32 s67, 1
    s_atomic_add s67, s[36:37], s3 glc
    s_waitcnt vmcnt(7)
    buffer_load_dwordx4 a[240:243], v2, s[12:15], s51 offen offset:0 nt
    s_waitcnt vmcnt(7)
    buffer_load_dwordx4 a[244:247], v2, s[12:15], s51 offen offset:1024 nt
    s_waitcnt vmcnt(7)
    buffer_load_dwordx4 a[248:251], v2, s[12:15], s51 offen offset:2048 nt
    s_waitcnt vmcnt(7)
    buffer_load_dwordx4 a[252:255], v2, s[12:15], s51 offen offset:3072 nt
    v_mfma_f32_16x16x32_bf16 v[48:51], v[192:195], v[16:19], 0
    v_mfma_f32_16x16x32_bf16 v[48:51], v[196:199], v[20:23], v[48:51]
    v_mfma_f32_16x16x32_bf16 v[48:51], v[200:203], v[24:27], v[48:51]
    v_mfma_f32_16x16x32_bf16 v[48:51], v[204:207], v[28:31], v[48:51]
    v_mul_f32_dpp v72, v170, v72 quad_perm:[0,0,0,0] row_mask:0xf bank_mask:0xf
    v_mul_f32_dpp v73, v170, v73 quad_perm:[1,1,1,1] row_mask:0xf bank_mask:0xf
    v_mul_f32_dpp v74, v170, v74 quad_perm:[2,2,2,2] row_mask:0xf bank_mask:0xf
    v_mul_f32_dpp v75, v170, v75 quad_perm:[3,3,3,3] row_mask:0xf bank_mask:0xf
    v_mul_f32_dpp v76, v170, v76 quad_perm:[0,0,0,0] row_mask:0xf bank_mask:0xf
    v_mul_f32_dpp v77, v170, v77 quad_perm:[1,1,1,1] row_mask:0xf bank_mask:0xf
    v_mul_f32_dpp v78, v170, v78 quad_perm:[2,2,2,2] row_mask:0xf bank_mask:0xf
    v_mul_f32_dpp v79, v170, v79 quad_perm:[3,3,3,3] row_mask:0xf bank_mask:0xf
    v_perm_b32 v80, v68, v68, v8
    v_perm_b32 v81, v68, v68, v9
    v_perm_b32 v82, v68, v68, v10
    v_perm_b32 v83, v68, v68, v11
    v_mfma_f32_16x16x16_bf16 v[72:75], v[80:81], a[224:225], v[72:75]
    v_mfma_f32_16x16x16_bf16 v[76:79], v[80:81], a[226:227], v[76:79]
    v_perm_b32 v84, v69, v69, v8
    v_perm_b32 v85, v69, v69, v9
    v_mfma_f32_16x16x16_bf16 v[72:75], v[82:83], a[228:229], v[72:75]
    v_mfma_f32_16x16x16_bf16 v[76:79], v[82:83], a[230:231], v[76:79]
    v_perm_b32 v86, v69, v69, v10
    v_perm_b32 v87, v69, v69, v11
    v_mfma_f32_16x16x16_bf16 v[72:75], v[84:85], a[232:233], v[72:75]
    v_mfma_f32_16x16x16_bf16 v[76:79], v[84:85], a[234:235], v[76:79]
    v_mfma_f32_16x16x16_bf16 v[72:75], v[86:87], a[236:237], v[72:75]
    v_mfma_f32_16x16x16_bf16 v[76:79], v[86:87], a[238:239], v[76:79]
    v_max3_f32 v88, v14, v48, v49
    v_max_f32 v89, v50, v51
    v_max_f32 v14, v88, v89
    v_mov_b32 v88, v14
    s_nop 1
    v_permlane32_swap_b32 v14, v88
    v_max_f32 v14, v14, v88
    v_mov_b32 v88, v14
    s_nop 1
    v_permlane16_swap_b32 v14, v88
    v_max_f32 v14, v14, v88
    v_mov_b32 v15, v12
    v_mul_f32 v12, s54, v14
    v_sub_f32 v169, v15, v12
    v_exp_f32 v169, v169
    s_nop 0
    v_mul_f32 v13, v13, v169
    v_fma_f32 v48, v48, s54, -v12
    v_fma_f32 v49, v49, s54, -v12
    v_fma_f32 v50, v50, s54, -v12
    v_fma_f32 v51, v51, s54, -v12
    v_exp_f32 v48, v48
    v_exp_f32 v49, v49
    v_exp_f32 v50, v50
    v_exp_f32 v51, v51
    v_add_f32 v88, v48, v49
    v_add_f32 v89, v50, v51
    v_add_f32 v90, v88, v89
    v_add_f32 v13, v90, v13
    v_cvt_pk_bf16_f32 v64, v48, v49
    v_cvt_pk_bf16_f32 v65, v50, v51
    s_nop 1
L_it0:
    s_waitcnt lgkmcnt(0)
    s_add_u32 s51, s67, 33
    s_cmp_ge_u32 s51, 96
    s_cbranch_scc1 L_exit1
    s_lshl_b32 s51, s51, 12
    s_add_u32 s51, s51, 1703936
    s_waitcnt vmcnt(7)
    buffer_load_dwordx4 v[192:195], v1, s[8:11], s51 offen offset:0 nt
    s_waitcnt vmcnt(7)
    buffer_load_dwordx4 v[196:199], v1, s[8:11], s51 offen offset:64 nt
    s_waitcnt vmcnt(7)
    buffer_load_dwordx4 v[200:203], v1, s[8:11], s51 offen offset:128 nt
    s_waitcnt vmcnt(7)
    buffer_load_dwordx4 v[204:207], v1, s[8:11], s51 offen offset:192 nt
    s_mov_b32 s67, 1
    s_atomic_add s67, s[36:37], s3 glc
    s_waitcnt vmcnt(7)
    buffer_load_dwordx4 a[224:227], v2, s[12:15], s52 offen offset:0 nt
    s_waitcnt vmcnt(7)
    buffer_load_dwordx4 a[228:231], v2, s[12:15], s52 offen offset:1024 nt
    s_waitcnt vmcnt(7)
    buffer_load_dwordx4 a[232:235], v2, s[12:15], s52 offen offset:2048 nt
    s_waitcnt vmcnt(7)
    buffer_load_dwordx4 a[236:239], v2, s[12:15], s52 offen offset:3072 nt
    v_mfma_f32_16x16x32_bf16 v[48:51], v[208:211], v[16:19], 0
    v_mfma_f32_16x16x32_bf16 v[48:51], v[212:215], v[20:23], v[48:51]
    v_mfma_f32_16x16x32_bf16 v[48:51], v[216:219], v[24:27], v[48:51]
    v_mfma_f32_16x16x32_bf16 v[48:51], v[220:223], v[28:31], v[48:51]
    v_mul_f32_dpp v72, v169, v72 quad_perm:[0,0,0,0] row_mask:0xf bank_mask:0xf
    v_mul_f32_dpp v73, v169, v73 quad_perm:[1,1,1,1] row_mask:0xf bank_mask:0xf
    v_mul_f32_dpp v74, v169, v74 quad_perm:[2,2,2,2] row_mask:0xf bank_mask:0xf
    v_mul_f32_dpp v75, v169, v75 quad_perm:[3,3,3,3] row_mask:0xf bank_mask:0xf
    v_mul_f32_dpp v76, v169, v76 quad_perm:[0,0,0,0] row_mask:0xf bank_mask:0xf
    v_mul_f32_dpp v77, v169, v77 quad_perm:[1,1,1,1] row_mask:0xf bank_mask:0xf
    v_mul_f32_dpp v78, v169, v78 quad_perm:[2,2,2,2] row_mask:0xf bank_mask:0xf
    v_mul_f32_dpp v79, v169, v79 quad_perm:[3,3,3,3] row_mask:0xf bank_mask:0xf
    v_perm_b32 v80, v64, v64, v8
    v_perm_b32 v81, v64, v64, v9
    v_perm_b32 v82, v64, v64, v10
    v_perm_b32 v83, v64, v64, v11
    v_mfma_f32_16x16x16_bf16 v[72:75], v[80:81], a[240:241], v[72:75]
    v_mfma_f32_16x16x16_bf16 v[76:79], v[80:81], a[242:243], v[76:79]
    v_perm_b32 v84, v65, v65, v8
    v_perm_b32 v85, v65, v65, v9
    v_mfma_f32_16x16x16_bf16 v[72:75], v[82:83], a[244:245], v[72:75]
    v_mfma_f32_16x16x16_bf16 v[76:79], v[82:83], a[246:247], v[76:79]
    v_perm_b32 v86, v65, v65, v10
    v_perm_b32 v87, v65, v65, v11
    v_mfma_f32_16x16x16_bf16 v[72:75], v[84:85], a[248:249], v[72:75]
    v_mfma_f32_16x16x16_bf16 v[76:79], v[84:85], a[250:251], v[76:79]
    v_mfma_f32_16x16x16_bf16 v[72:75], v[86:87], a[252:253], v[72:75]
    v_mfma_f32_16x16x16_bf16 v[76:79], v[86:87], a[254:255], v[76:79]
    v_max3_f32 v88, v14, v48, v49
    v_max_f32 v89, v50, v51
    v_max_f32 v14, v88, v89
    v_mov_b32 v88, v14
    s_nop 1
    v_permlane32_swap_b32 v14, v88
    v_max_f32 v14, v14, v88
    v_mov_b32 v88, v14
    s_nop 1
    v_permlane16_swap_b32 v14, v88
    v_max_f32 v14, v14, v88
    v_mov_b32 v15, v12
    v_mul_f32 v12, s54, v14
    v_sub_f32 v170, v15, v12
    v_exp_f32 v170, v170
    s_nop 0
    v_mul_f32 v13, v13, v170
    v_fma_f32 v48, v48, s54, -v12
    v_fma_f32 v49, v49, s54, -v12
    v_fma_f32 v50, v50, s54, -v12
    v_fma_f32 v51, v51, s54, -v12
    v_exp_f32 v48, v48
    v_exp_f32 v49, v49
    v_exp_f32 v50, v50
    v_exp_f32 v51, v51
    v_add_f32 v88, v48, v49
    v_add_f32 v89, v50, v51
    v_add_f32 v90, v88, v89
    v_add_f32 v13, v90, v13
    v_cvt_pk_bf16_f32 v68, v48, v49
    v_cvt_pk_bf16_f32 v69, v50, v51
    s_nop 1
    s_branch L_it1
L_exit1:
    buffer_load_dwordx4 a[224:227], v2, s[12:15], s52 offen offset:0 nt
    buffer_load_dwordx4 a[228:231], v2, s[12:15], s52 offen offset:1024 nt
    buffer_load_dwordx4 a[232:235], v2, s[12:15], s52 offen offset:2048 nt
    buffer_load_dwordx4 a[236:239], v2, s[12:15], s52 offen offset:3072 nt
    s_waitcnt vmcnt(8)
    v_mfma_f32_16x16x32_bf16 v[48:51], v[208:211], v[16:19], 0
    v_mfma_f32_16x16x32_bf16 v[48:51], v[212:215], v[20:23], v[48:51]
    v_mfma_f32_16x16x32_bf16 v[48:51], v[216:219], v[24:27], v[48:51]
    v_mfma_f32_16x16x32_bf16 v[48:51], v[220:223], v[28:31], v[48:51]
    v_mul_f32_dpp v72, v169, v72 quad_perm:[0,0,0,0] row_mask:0xf bank_mask:0xf
    v_mul_f32_dpp v73, v169, v73 quad_perm:[1,1,1,1] row_mask:0xf bank_mask:0xf
    v_mul_f32_dpp v74, v169, v74 quad_perm:[2,2,2,2] row_mask:0xf bank_mask:0xf
    v_mul_f32_dpp v75, v169, v75 quad_perm:[3,3,3,3] row_mask:0xf bank_mask:0xf
    v_mul_f32_dpp v76, v169, v76 quad_perm:[0,0,0,0] row_mask:0xf bank_mask:0xf
    v_mul_f32_dpp v77, v169, v77 quad_perm:[1,1,1,1] row_mask:0xf bank_mask:0xf
    v_mul_f32_dpp v78, v169, v78 quad_perm:[2,2,2,2] row_mask:0xf bank_mask:0xf
    v_mul_f32_dpp v79, v169, v79 quad_perm:[3,3,3,3] row_mask:0xf bank_mask:0xf
    v_max3_f32 v88, v14, v48, v49
    v_max_f32 v89, v50, v51
    v_max_f32 v14, v88, v89
    v_mov_b32 v88, v14
    s_nop 1
    v_permlane32_swap_b32 v14, v88
    v_max_f32 v14, v14, v88
    v_mov_b32 v88, v14
    s_nop 1
    v_permlane16_swap_b32 v14, v88
    v_max_f32 v14, v14, v88
    v_mov_b32 v15, v12
    v_mul_f32 v12, s54, v14
    v_sub_f32 v88, v15, v12
    v_exp_f32 v88, v88
    s_nop 0
    v_mul_f32 v13, v13, v88
    v_fma_f32 v48, v48, s54, -v12
    v_fma_f32 v49, v49, s54, -v12
    v_fma_f32 v50, v50, s54, -v12
    v_fma_f32 v51, v51, s54, -v12
    v_exp_f32 v48, v48
    v_exp_f32 v49, v49
    v_exp_f32 v50, v50
    v_exp_f32 v51, v51
    v_add_f32 v88, v48, v49
    v_add_f32 v89, v50, v51
    v_add_f32 v90, v88, v89
    v_add_f32 v13, v90, v13
    v_mov_b32 v88, v13
    s_nop 1
    v_permlane32_swap_b32 v13, v88
    v_add_f32 v13, v13, v88
    v_mov_b32 v88, v13
    s_nop 1
    v_permlane16_swap_b32 v13, v88
    v_add_f32 v13, v13, v88
    ds_write_b64 v176, v[12:13] offset:4224
    v_mov_b32 v4, 0
    v_mov_b32 v5, s67
    s_mov_b64 exec, 1
    ds_max_u32 v4, v5 offset:4376
    s_mov_b64 exec, -1
    s_waitcnt lgkmcnt(0)
    s_barrier
    ds_read_b64 v[88:89], v121 offset:4224
    ds_read_b64 v[90:91], v121 offset:4256
    ds_read_b64 v[92:93], v121 offset:4288
    ds_read_b64 v[94:95], v121 offset:4320
    ds_read_b32 v5, v4 offset:4376
    s_waitcnt lgkmcnt(0)
    v_readfirstlane_b32 s67, v5
    s_mov_b32 s25, s30
    s_cmp_ge_u32 s61, 8
    s_cselect_b32 s5, 0, 0
    s_add_u32 s5, s5, 75
    s_cmp_ge_u32 s67, s5
    s_cselect_b32 s30, s30, 0
    v_max3_f32 v96, v88, v90, v92
    v_max_f32 v96, v96, v94
    v_sub_f32 v88, v88, v96
    v_sub_f32 v90, v90, v96
    v_sub_f32 v92, v92, v96
    v_sub_f32 v94, v94, v96
    v_exp_f32 v88, v88
    v_exp_f32 v90, v90
    v_exp_f32 v92, v92
    v_exp_f32 v94, v94
    v_mul_f32 v97, v88, v89
    v_fmac_f32 v97, v90, v91
    v_fmac_f32 v97, v92, v93
    v_fmac_f32 v97, v94, v95
    s_add_u32 s5, s4, 0
    buffer_store_dwordx2 v[96:97], v168, s[36:39], s5 offen sc1
    buffer_load_dword v188, v185, s[36:39], 0 offen sc1
    s_add_u32 m0, s57, 0
    s_mov_b32 s53, 0
    buffer_load_dwordx4 v125, s[28:31], s53 offen nt lds
    v_sub_f32 v98, v12, v96
    v_exp_f32 v98, v98
    v_sub_f32 v99, v15, v96
    v_exp_f32 v99, v99
    v_mul_f32 v48, v48, v98
    v_mul_f32 v49, v49, v98
    s_add_u32 m0, s57, 1024
    s_mov_b32 s53, 262144
    buffer_load_dwordx4 v125, s[28:31], s53 offen nt lds
    v_mul_f32 v50, v50, v98
    v_mul_f32 v51, v51, v98
    v_cvt_pk_bf16_f32 v68, v48, v49
    v_cvt_pk_bf16_f32 v69, v50, v51
    s_waitcnt vmcnt(8)
    v_perm_b32 v80, v64, v64, v8
    s_add_u32 m0, s57, 2048
    s_mov_b32 s53, 8192
    buffer_load_dwordx4 v125, s[28:31], s53 offen nt lds
    v_perm_b32 v81, v64, v64, v9
    v_perm_b32 v82, v64, v64, v10
    v_perm_b32 v83, v64, v64, v11
    v_mfma_f32_16x16x16_bf16 v[72:75], v[80:81], a[240:241], v[72:75]
    v_mfma_f32_16x16x16_bf16 v[76:79], v[80:81], a[242:243], v[76:79]
    v_perm_b32 v84, v65, v65, v8
    s_add_u32 m0, s57, 3072
    s_mov_b32 s53, 270336
    buffer_load_dwordx4 v125, s[28:31], s53 offen nt lds
    v_perm_b32 v85, v65, v65, v9
    v_mfma_f32_16x16x16_bf16 v[72:75], v[82:83], a[244:245], v[72:75]
    v_mfma_f32_16x16x16_bf16 v[76:79], v[82:83], a[246:247], v[76:79]
    v_perm_b32 v86, v65, v65, v10
    v_perm_b32 v87, v65, v65, v11
    v_mfma_f32_16x16x16_bf16 v[72:75], v[84:85], a[248:249], v[72:75]
    s_add_u32 m0, s57, 4096
    s_mov_b32 s53, 16384
    buffer_load_dwordx4 v125, s[28:31], s53 offen nt lds
    v_mfma_f32_16x16x16_bf16 v[76:79], v[84:85], a[250:251], v[76:79]
    v_mfma_f32_16x16x16_bf16 v[72:75], v[86:87], a[252:253], v[72:75]
    v_mfma_f32_16x16x16_bf16 v[76:79], v[86:87], a[254:255], v[76:79]
    v_perm_b32 v80, v68, v68, v8
    v_perm_b32 v81, v68, v68, v9
    v_perm_b32 v82, v68, v68, v10
    s_add_u32 m0, s57, 5120
    s_mov_b32 s53, 278528
    buffer_load_dwordx4 v125, s[28:31], s53 offen nt lds
    v_perm_b32 v83, v68, v68, v11
    v_perm_b32 v84, v69, v69, v8
    v_perm_b32 v85, v69, v69, v9
    v_perm_b32 v86, v69, v69, v10
    v_perm_b32 v87, v69, v69, v11
    v_mul_f32_dpp v72, v99, v72 quad_perm:[0,0,0,0] row_mask:0xf bank_mask:0xf
    s_add_u32 m0, s57, 6144
    s_mov_b32 s53, 24576
    buffer_load_dwordx4 v125, s[28:31], s53 offen nt lds
    v_mul_f32_dpp v73, v99, v73 quad_perm:[1,1,1,1] row_mask:0xf bank_mask:0xf
    v_mul_f32_dpp v74, v99, v74 quad_perm:[2,2,2,2] row_mask:0xf bank_mask:0xf
    v_mul_f32_dpp v75, v99, v75 quad_perm:[3,3,3,3] row_mask:0xf bank_mask:0xf
    v_mul_f32_dpp v76, v99, v76 quad_perm:[0,0,0,0] row_mask:0xf bank_mask:0xf
    v_mul_f32_dpp v77, v99, v77 quad_perm:[1,1,1,1] row_mask:0xf bank_mask:0xf
    v_mul_f32_dpp v78, v99, v78 quad_perm:[2,2,2,2] row_mask:0xf bank_mask:0xf
    s_add_u32 m0, s57, 7168
    s_mov_b32 s53, 286720
    buffer_load_dwordx4 v125, s[28:31], s53 offen nt lds
    v_mul_f32_dpp v79, v99, v79 quad_perm:[3,3,3,3] row_mask:0xf bank_mask:0xf
    s_waitcnt vmcnt(13)
    v_mfma_f32_16x16x16_bf16 v[72:75], v[80:81], a[224:225], v[72:75]
    v_mfma_f32_16x16x16_bf16 v[76:79], v[80:81], a[226:227], v[76:79]
    s_waitcnt vmcnt(12)
    v_mfma_f32_16x16x16_bf16 v[72:75], v[82:83], a[228:229], v[72:75]
    v_mfma_f32_16x16x16_bf16 v[76:79], v[82:83], a[230:231], v[76:79]
    s_waitcnt vmcnt(11)
    v_mfma_f32_16x16x16_bf16 v[72:75], v[84:85], a[232:233], v[72:75]
    v_mfma_f32_16x16x16_bf16 v[76:79], v[84:85], a[234:235], v[76:79]
    s_waitcnt vmcnt(10)
    v_mfma_f32_16x16x16_bf16 v[72:75], v[86:87], a[236:237], v[72:75]
    v_mfma_f32_16x16x16_bf16 v[76:79], v[86:87], a[238:239], v[76:79]
    s_nop 7
    s_branch L_tail
L_exit0:
    buffer_load_dwordx4 a[240:243], v2, s[12:15], s51 offen offset:0 nt
    buffer_load_dwordx4 a[244:247], v2, s[12:15], s51 offen offset:1024 nt
    buffer_load_dwordx4 a[248:251], v2, s[12:15], s51 offen offset:2048 nt
    buffer_load_dwordx4 a[252:255], v2, s[12:15], s51 offen offset:3072 nt
    s_waitcnt vmcnt(8)
    v_mfma_f32_16x16x32_bf16 v[48:51], v[192:195], v[16:19], 0
    v_mfma_f32_16x16x32_bf16 v[48:51], v[196:199], v[20:23], v[48:51]
    v_mfma_f32_16x16x32_bf16 v[48:51], v[200:203], v[24:27], v[48:51]
    v_mfma_f32_16x16x32_bf16 v[48:51], v[204:207], v[28:31], v[48:51]
    v_mul_f32_dpp v72, v170, v72 quad_perm:[0,0,0,0] row_mask:0xf bank_mask:0xf
    v_mul_f32_dpp v73, v170, v73 quad_perm:[1,1,1,1] row_mask:0xf bank_mask:0xf
    v_mul_f32_dpp v74, v170, v74 quad_perm:[2,2,2,2] row_mask:0xf bank_mask:0xf
    v_mul_f32_dpp v75, v170, v75 quad_perm:[3,3,3,3] row_mask:0xf bank_mask:0xf
    v_mul_f32_dpp v76, v170, v76 quad_perm:[0,0,0,0] row_mask:0xf bank_mask:0xf
    v_mul_f32_dpp v77, v170, v77 quad_perm:[1,1,1,1] row_mask:0xf bank_mask:0xf
    v_mul_f32_dpp v78, v170, v78 quad_perm:[2,2,2,2] row_mask:0xf bank_mask:0xf
    v_mul_f32_dpp v79, v170, v79 quad_perm:[3,3,3,3] row_mask:0xf bank_mask:0xf
    v_max3_f32 v88, v14, v48, v49
    v_max_f32 v89, v50, v51
    v_max_f32 v14, v88, v89
    v_mov_b32 v88, v14
    s_nop 1
    v_permlane32_swap_b32 v14, v88
    v_max_f32 v14, v14, v88
    v_mov_b32 v88, v14
    s_nop 1
    v_permlane16_swap_b32 v14, v88
    v_max_f32 v14, v14, v88
    v_mov_b32 v15, v12
    v_mul_f32 v12, s54, v14
    v_sub_f32 v88, v15, v12
    v_exp_f32 v88, v88
    s_nop 0
    v_mul_f32 v13, v13, v88
    v_fma_f32 v48, v48, s54, -v12
    v_fma_f32 v49, v49, s54, -v12
    v_fma_f32 v50, v50, s54, -v12
    v_fma_f32 v51, v51, s54, -v12
    v_exp_f32 v48, v48
    v_exp_f32 v49, v49
    v_exp_f32 v50, v50
    v_exp_f32 v51, v51
    v_add_f32 v88, v48, v49
    v_add_f32 v89, v50, v51
    v_add_f32 v90, v88, v89
    v_add_f32 v13, v90, v13
    v_mov_b32 v88, v13
    s_nop 1
    v_permlane32_swap_b32 v13, v88
    v_add_f32 v13, v13, v88
    v_mov_b32 v88, v13
    s_nop 1
    v_permlane16_swap_b32 v13, v88
    v_add_f32 v13, v13, v88
    ds_write_b64 v176, v[12:13] offset:4224
    v_mov_b32 v4, 0
    v_mov_b32 v5, s67
    s_mov_b64 exec, 1
    ds_max_u32 v4, v5 offset:4376
    s_mov_b64 exec, -1
    s_waitcnt lgkmcnt(0)
    s_barrier
    ds_read_b64 v[88:89], v121 offset:4224
    ds_read_b64 v[90:91], v121 offset:4256
    ds_read_b64 v[92:93], v121 offset:4288
    ds_read_b64 v[94:95], v121 offset:4320
    ds_read_b32 v5, v4 offset:4376
    s_waitcnt lgkmcnt(0)
    v_readfirstlane_b32 s67, v5
    s_mov_b32 s25, s30
    s_cmp_ge_u32 s61, 8
    s_cselect_b32 s5, 0, 0
    s_add_u32 s5, s5, 75
    s_cmp_ge_u32 s67, s5
    s_cselect_b32 s30, s30, 0
    v_max3_f32 v96, v88, v90, v92
    v_max_f32 v96, v96, v94
    v_sub_f32 v88, v88, v96
    v_sub_f32 v90, v90, v96
    v_sub_f32 v92, v92, v96
    v_sub_f32 v94, v94, v96
    v_exp_f32 v88, v88
    v_exp_f32 v90, v90
    v_exp_f32 v92, v92
    v_exp_f32 v94, v94
    v_mul_f32 v97, v88, v89
    v_fmac_f32 v97, v90, v91
    v_fmac_f32 v97, v92, v93
    v_fmac_f32 v97, v94, v95
    s_add_u32 s5, s4, 0
    buffer_store_dwordx2 v[96:97], v168, s[36:39], s5 offen sc1
    buffer_load_dword v188, v185, s[36:39], 0 offen sc1
    s_add_u32 m0, s57, 0
    s_mov_b32 s53, 0
    buffer_load_dwordx4 v125, s[28:31], s53 offen nt lds
    v_sub_f32 v98, v12, v96
    v_exp_f32 v98, v98
    v_sub_f32 v99, v15, v96
    v_exp_f32 v99, v99
    v_mul_f32 v48, v48, v98
    v_mul_f32 v49, v49, v98
    s_add_u32 m0, s57, 1024
    s_mov_b32 s53, 262144
    buffer_load_dwordx4 v125, s[28:31], s53 offen nt lds
    v_mul_f32 v50, v50, v98
    v_mul_f32 v51, v51, v98
    v_cvt_pk_bf16_f32 v64, v48, v49
    v_cvt_pk_bf16_f32 v65, v50, v51
    s_waitcnt vmcnt(8)
    v_perm_b32 v80, v68, v68, v8
    s_add_u32 m0, s57, 2048
    s_mov_b32 s53, 8192
    buffer_load_dwordx4 v125, s[28:31], s53 offen nt lds
    v_perm_b32 v81, v68, v68, v9
    v_perm_b32 v82, v68, v68, v10
    v_perm_b32 v83, v68, v68, v11
    v_mfma_f32_16x16x16_bf16 v[72:75], v[80:81], a[224:225], v[72:75]
    v_mfma_f32_16x16x16_bf16 v[76:79], v[80:81], a[226:227], v[76:79]
    v_perm_b32 v84, v69, v69, v8
    s_add_u32 m0, s57, 3072
    s_mov_b32 s53, 270336
    buffer_load_dwordx4 v125, s[28:31], s53 offen nt lds
    v_perm_b32 v85, v69, v69, v9
    v_mfma_f32_16x16x16_bf16 v[72:75], v[82:83], a[228:229], v[72:75]
    v_mfma_f32_16x16x16_bf16 v[76:79], v[82:83], a[230:231], v[76:79]
    v_perm_b32 v86, v69, v69, v10
    v_perm_b32 v87, v69, v69, v11
    v_mfma_f32_16x16x16_bf16 v[72:75], v[84:85], a[232:233], v[72:75]
    s_add_u32 m0, s57, 4096
    s_mov_b32 s53, 16384
    buffer_load_dwordx4 v125, s[28:31], s53 offen nt lds
    v_mfma_f32_16x16x16_bf16 v[76:79], v[84:85], a[234:235], v[76:79]
    v_mfma_f32_16x16x16_bf16 v[72:75], v[86:87], a[236:237], v[72:75]
    v_mfma_f32_16x16x16_bf16 v[76:79], v[86:87], a[238:239], v[76:79]
    v_perm_b32 v80, v64, v64, v8
    v_perm_b32 v81, v64, v64, v9
    v_perm_b32 v82, v64, v64, v10
    s_add_u32 m0, s57, 5120
    s_mov_b32 s53, 278528
    buffer_load_dwordx4 v125, s[28:31], s53 offen nt lds
    v_perm_b32 v83, v64, v64, v11
    v_perm_b32 v84, v65, v65, v8
    v_perm_b32 v85, v65, v65, v9
    v_perm_b32 v86, v65, v65, v10
    v_perm_b32 v87, v65, v65, v11
    v_mul_f32_dpp v72, v99, v72 quad_perm:[0,0,0,0] row_mask:0xf bank_mask:0xf
    s_add_u32 m0, s57, 6144
    s_mov_b32 s53, 24576
    buffer_load_dwordx4 v125, s[28:31], s53 offen nt lds
    v_mul_f32_dpp v73, v99, v73 quad_perm:[1,1,1,1] row_mask:0xf bank_mask:0xf
    v_mul_f32_dpp v74, v99, v74 quad_perm:[2,2,2,2] row_mask:0xf bank_mask:0xf
    v_mul_f32_dpp v75, v99, v75 quad_perm:[3,3,3,3] row_mask:0xf bank_mask:0xf
    v_mul_f32_dpp v76, v99, v76 quad_perm:[0,0,0,0] row_mask:0xf bank_mask:0xf
    v_mul_f32_dpp v77, v99, v77 quad_perm:[1,1,1,1] row_mask:0xf bank_mask:0xf
    v_mul_f32_dpp v78, v99, v78 quad_perm:[2,2,2,2] row_mask:0xf bank_mask:0xf
    s_add_u32 m0, s57, 7168
    s_mov_b32 s53, 286720
    buffer_load_dwordx4 v125, s[28:31], s53 offen nt lds
    v_mul_f32_dpp v79, v99, v79 quad_perm:[3,3,3,3] row_mask:0xf bank_mask:0xf
    s_waitcnt vmcnt(13)
    v_mfma_f32_16x16x16_bf16 v[72:75], v[80:81], a[240:241], v[72:75]
    v_mfma_f32_16x16x16_bf16 v[76:79], v[80:81], a[242:243], v[76:79]
    s_waitcnt vmcnt(12)
    v_mfma_f32_16x16x16_bf16 v[72:75], v[82:83], a[244:245], v[72:75]
    v_mfma_f32_16x16x16_bf16 v[76:79], v[82:83], a[246:247], v[76:79]
    s_waitcnt vmcnt(11)
    v_mfma_f32_16x16x16_bf16 v[72:75], v[84:85], a[248:249], v[72:75]
    v_mfma_f32_16x16x16_bf16 v[76:79], v[84:85], a[250:251], v[76:79]
    s_waitcnt vmcnt(10)
    v_mfma_f32_16x16x16_bf16 v[72:75], v[86:87], a[252:253], v[72:75]
    v_mfma_f32_16x16x16_bf16 v[76:79], v[86:87], a[254:255], v[76:79]
    s_nop 7
L_tail:
    ds_write_b128 v120, v[72:75] offset:12608
    ds_write_b128 v120, v[76:79] offset:13632
    s_waitcnt lgkmcnt(0)
    s_barrier
    s_cmp_lg_u32 s48, 0
    s_cbranch_scc1 L_oa_skip
    ds_read_b128 v[96:99], v2 offset:14656
    ds_read_b128 v[100:103], v2 offset:15680
    ds_read_b128 v[104:107], v2 offset:16704
    ds_read_b128 v[108:111], v2 offset:17728
    ds_read_b128 v[112:115], v2 offset:18752
    ds_read_b128 v[116:119], v2 offset:19776
    s_waitcnt lgkmcnt(0)
    v_pk_add_f32 v[88:89], v[72:73], v[96:97]
    v_pk_add_f32 v[104:105], v[104:105], v[112:113]
    v_pk_add_f32 v[90:91], v[74:75], v[98:99]
    v_pk_add_f32 v[106:107], v[106:107], v[114:115]
    v_pk_add_f32 v[92:93], v[76:77], v[100:101]
    v_pk_add_f32 v[108:109], v[108:109], v[116:117]
    v_pk_add_f32 v[94:95], v[78:79], v[102:103]
    v_pk_add_f32 v[110:111], v[110:111], v[118:119]
    v_pk_add_f32 v[88:89], v[88:89], v[104:105]
    v_pk_add_f32 v[90:91], v[90:91], v[106:107]
    v_pk_add_f32 v[92:93], v[92:93], v[108:109]
    v_pk_add_f32 v[94:95], v[94:95], v[110:111]
    v_cvt_pk_bf16_f32 v88, v88, v89
    v_cvt_pk_bf16_f32 v89, v90, v91
    v_cvt_pk_bf16_f32 v90, v92, v93
    v_cvt_pk_bf16_f32 v91, v94, v95
    buffer_store_dwordx4 v[88:91], v171, s[36:39], 0 offen sc1
L_oa_skip:
    s_mov_b32 s16, 117835008
    s_mov_b32 s17, 117835009
    s_mov_b32 s18, 117835010
    s_mov_b32 s19, 117835011
    s_mov_b32 s20, 0x0c0c0400
    s_mov_b32 s21, 0x04000c0c
    s_mov_b32 s22, 0xffffff00
    s_cmp_lg_u32 s30, 0
    s_cbranch_scc1 L_wd
    s_mov_b32 s30, s25
    s_add_u32 m0, s57, 0
    s_mov_b32 s53, 0
    buffer_load_dwordx4 v125, s[28:31], s53 offen nt lds
    s_add_u32 m0, s57, 1024
    s_mov_b32 s53, 262144
    buffer_load_dwordx4 v125, s[28:31], s53 offen nt lds
    s_add_u32 m0, s57, 2048
    s_mov_b32 s53, 8192
    buffer_load_dwordx4 v125, s[28:31], s53 offen nt lds
    s_add_u32 m0, s57, 3072
    s_mov_b32 s53, 270336
    buffer_load_dwordx4 v125, s[28:31], s53 offen nt lds
    s_add_u32 m0, s57, 4096
    s_mov_b32 s53, 16384
    buffer_load_dwordx4 v125, s[28:31], s53 offen nt lds
    s_add_u32 m0, s57, 5120
    s_mov_b32 s53, 278528
    buffer_load_dwordx4 v125, s[28:31], s53 offen nt lds
    s_add_u32 m0, s57, 6144
    s_mov_b32 s53, 24576
    buffer_load_dwordx4 v125, s[28:31], s53 offen nt lds
    s_add_u32 m0, s57, 7168
    s_mov_b32 s53, 286720
    buffer_load_dwordx4 v125, s[28:31], s53 offen nt lds
    s_waitcnt vmcnt(0)
L_wd:
    s_waitcnt vmcnt(1)
    s_cmp_eq_u32 s48, 0
    s_cbranch_scc1 L_w2_1
    s_waitcnt vmcnt(0)
L_w2_1:
    buffer_load_dwordx4 v[32:35], v126, s[36:39], 0 offen sc1
    s_barrier
    ds_read_b64_tr_b16 v[192:193], v174 offset:0
    ds_read_b64_tr_b16 v[194:195], v174 offset:1024
    ds_read_b64_tr_b16 v[196:197], v174 offset:32
    ds_read_b64_tr_b16 v[198:199], v174 offset:1056
    ds_read_b64_tr_b16 v[200:201], v174 offset:32768
    ds_read_b64_tr_b16 v[202:203], v174 offset:33792
    ds_read_b64_tr_b16 v[204:205], v174 offset:32800
    ds_read_b64_tr_b16 v[206:207], v174 offset:33824
    ds_read_b64_tr_b16 v[208:209], v177 offset:0
    ds_read_b64_tr_b16 v[210:211], v177 offset:1024
    ds_read_b64_tr_b16 v[212:213], v177 offset:32
    ds_read_b64_tr_b16 v[214:215], v177 offset:1056
    ds_read_b64_tr_b16 v[216:217], v177 offset:32768
    ds_read_b64_tr_b16 v[218:219], v177 offset:33792
    ds_read_b64_tr_b16 v[220:221], v177 offset:32800
    ds_read_b64_tr_b16 v[222:223], v177 offset:33824
    s_mov_b32 s56, 100000
    s_waitcnt vmcnt(0)
    s_branch L_ml_chk
L_ml_loop:
    buffer_load_dwordx4 v[32:35], v126, s[36:39], 0 offen sc1
    s_sub_u32 s56, s56, 1
    s_cbranch_scc1 L_ml_ok
    s_waitcnt vmcnt(0)
L_ml_chk:
    v_max3_u32 v3, v32, v33, v34
    v_max_u32 v3, v3, v35
    v_cmp_eq_u32 vcc, -1, v3
    s_nop 0
    s_cbranch_vccnz L_ml_loop
L_ml_ok:
    s_cmp_ge_u32 s61, 8
    s_cbranch_scc1 L_b_read
    buffer_load_dwordx4 v[136:139], v127, s[36:39], 0 offen sc1
    buffer_load_dwordx4 v[140:143], v127, s[36:39], s65 offen sc1
    v_max_f32 v88, v32, v34
    v_mov_b32 v89, v88
    s_nop 1
    v_permlane32_swap_b32 v88, v89
    v_max_f32 v88, v88, v89
    v_mov_b32 v89, v88
    s_nop 1
    v_permlane16_swap_b32 v88, v89
    v_max_f32 v88, v88, v89
    v_sub_f32 v32, v32, v88
    v_sub_f32 v34, v34, v88
    v_exp_f32 v32, v32
    v_exp_f32 v34, v34
    v_mul_f32 v88, v32, v33
    v_fmac_f32 v88, v34, v35
    v_mov_b32 v89, v88
    s_nop 1
    v_permlane32_swap_b32 v88, v89
    v_add_f32 v88, v88, v89
    v_mov_b32 v89, v88
    s_nop 1
    v_permlane16_swap_b32 v88, v89
    v_add_f32 v88, v88, v89
    v_rcp_f32 v88, v88
    s_nop 0
    v_mul_f32 v32, v32, v88
    v_mul_f32 v34, v34, v88
    v_cvt_pk_bf16_f32 v64, v32, v34
    v_perm_b32 v80, v64, v64, v8
    v_perm_b32 v81, v64, v64, v9
    v_perm_b32 v82, v64, v64, v10
    v_perm_b32 v83, v64, v64, v11
    s_mov_b32 s56, 100000
    s_waitcnt vmcnt(0)
    s_branch L_o_chk
L_o_loop:
    buffer_load_dwordx4 v[136:139], v127, s[36:39], 0 offen sc1
    buffer_load_dwordx4 v[140:143], v127, s[36:39], s65 offen sc1
    s_sub_u32 s56, s56, 1
    s_cbranch_scc1 L_o_ok
    s_waitcnt vmcnt(0)
L_o_chk:
    v_mfma_f32_16x16x16_bf16 v[72:75], v[80:81], v[136:137], 0
    v_mfma_f32_16x16x16_bf16 v[76:79], v[80:81], v[138:139], 0
    v_mfma_f32_16x16x16_bf16 v[72:75], v[82:83], v[140:141], v[72:75]
    v_mfma_f32_16x16x16_bf16 v[76:79], v[82:83], v[142:143], v[76:79]
    v_max3_u32 v3, v136, v137, v138
    v_max3_u32 v3, v3, v139, v140
    v_max3_u32 v3, v3, v141, v142
    v_max_u32 v3, v3, v143
    v_cmp_eq_u32 vcc, -1, v3
    s_nop 0
    s_cbranch_vccnz L_o_loop
L_o_ok:
    s_nop 0
    v_cvt_pk_bf16_f32 v88, v72, v76
    ds_write_b32 v172, v88 offset:0
L_o_put:
    s_waitcnt lgkmcnt(0)
    s_barrier
    ds_read_b128 v[48:51], v173 offset:0
    ds_read_b128 v[52:55], v173 offset:64
    ds_read_b128 v[56:59], v173 offset:128
    ds_read_b128 v[60:63], v173 offset:192
    s_waitcnt lgkmcnt(3)
    v_mfma_f32_16x16x32_bf16 v[72:75], v[192:195], v[48:51], 0
    v_mfma_f32_16x16x32_bf16 v[76:79], v[196:199], v[48:51], 0
    s_waitcnt lgkmcnt(2)
    v_mfma_f32_16x16x32_bf16 v[72:75], v[200:203], v[52:55], v[72:75]
    v_mfma_f32_16x16x32_bf16 v[76:79], v[204:207], v[52:55], v[76:79]
    s_waitcnt lgkmcnt(1)
    v_mfma_f32_16x16x32_bf16 v[72:75], v[208:211], v[56:59], v[72:75]
    v_mfma_f32_16x16x32_bf16 v[76:79], v[212:215], v[56:59], v[76:79]
    s_waitcnt lgkmcnt(0)
    v_mfma_f32_16x16x32_bf16 v[72:75], v[216:219], v[60:63], v[72:75]
    v_mfma_f32_16x16x32_bf16 v[76:79], v[220:223], v[60:63], v[76:79]
    s_nop 6
    v_perm_b32 v72, v72, v184, s16
    v_perm_b32 v73, v73, v184, s17
    v_perm_b32 v74, v74, v184, s18
    v_perm_b32 v75, v75, v184, s19
    v_perm_b32 v76, v76, v184, s16
    v_perm_b32 v77, v77, v184, s17
    v_perm_b32 v78, v78, v184, s18
    v_perm_b32 v79, v79, v184, s19
    s_cmp_eq_u32 s55, 0
    s_cbranch_scc1 L_p2_far
    buffer_store_dwordx4 v[72:75], v175, s[36:39], 0 offen offset:0
    buffer_store_dwordx4 v[76:79], v175, s[36:39], 0 offen offset:256
L_p2_stored:
    s_cmp_lg_u32 s48, 0
    s_cbranch_scc1 L_end
    s_add_u32 s6, s63, 32768
    s_mov_b32 s56, 100000
    buffer_load_dwordx4 v[48:51], v178, s[36:39], s63 offen sc1
    buffer_load_dwordx4 v[52:55], v178, s[36:39], s6 offen sc1
L_p2_loop:
    buffer_load_dwordx4 v[48:51], v178, s[36:39], s63 offen sc1
    buffer_load_dwordx4 v[52:55], v178, s[36:39], s6 offen sc1
    s_sub_u32 s56, s56, 1
    s_cbranch_scc1 L_p2_ok
    s_waitcnt vmcnt(2)
    v_perm_b32 v88, v49, v48, s20
    v_perm_b32 v89, v51, v50, s21
    v_perm_b32 v90, v53, v52, s20
    v_perm_b32 v91, v55, v54, s21
    v_xor_b32 v88, v88, v184
    v_xor_b32 v90, v90, v184
    v_xor_b32 v88, v88, v89
    v_xor_b32 v90, v90, v91
    v_or_b32 v88, v88, v90
    v_cmp_ne_u32 vcc, 0, v88
    s_nop 0
    s_cbranch_vccnz L_p2_loop
L_p2_ok:
    v_and_b32 v96, s22, v48
    v_and_b32 v97, s22, v49
    v_and_b32 v98, s22, v50
    v_and_b32 v99, s22, v51
    v_and_b32 v100, s22, v52
    v_and_b32 v101, s22, v53
    v_and_b32 v102, s22, v54
    v_and_b32 v103, s22, v55
    v_pk_add_f32 v[96:97], v[96:97], v[100:101]
    v_pk_add_f32 v[98:99], v[98:99], v[102:103]
    s_nop 0
    v_permlane32_swap_b32 v96, v97
    v_permlane32_swap_b32 v98, v99
    v_add_f32 v96, v96, v97
    v_add_f32 v98, v98, v99
    s_nop 1
    v_permlane16_swap_b32 v96, v98
    v_add_f32 v96, v96, v98
    s_nop 1
    v_add_f32_dpp v96, v96, v96 row_ror:4 row_mask:0xf bank_mask:0xf
    s_nop 1
    v_add_f32_dpp v96, v96, v96 row_ror:8 row_mask:0xf bank_mask:0xf
    v_cvt_pk_bf16_f32 v96, v96, v96
    buffer_store_short v96, v179, s[44:47], s64 offen
L_end:
    s_endpgm
L_p0_slow:
    s_mov_b32 s56, 100000
    v_and_b32 v4, 7, v0
    v_lshlrev_b32 v4, 5, v4
L_p0_loop:
    buffer_load_dwordx2 v[180:181], v4, s[40:43], 0 offen sc1
    s_sub_u32 s56, s56, 1
    s_waitcnt vmcnt(0)
    s_cbranch_scc1 L_p0_ok
    v_and_b32 v5, 0xff, v180
    v_cmp_gt_u32 vcc, 32, v5
    s_nop 0
    s_cbranch_vccnz L_p0_loop
    s_branch L_p0_ok
L_far1:
    buffer_store_dwordx4 v[88:91], v186, s[36:39], s5 offen sc1
    s_branch L_near1
L_far2:
    buffer_store_dwordx2 v[182:183], v4, s[36:39], s5 offen sc1
    s_branch L_near2
L_b_read:
    v_and_b32 v4, -16, v172
    ds_write_b128 v4, v[32:35] offset:0
    s_branch L_o_put
L_p2_far:
    buffer_store_dwordx4 v[72:75], v175, s[36:39], 0 offen offset:0 sc1
    buffer_store_dwordx4 v[76:79], v175, s[36:39], 0 offen offset:256 sc1
    s_branch L_p2_stored
L_code_end:
.section .rodata,"a"
.p2align 6
.amdhsa_kernel concat_heads__gqa_block_cached__sliding_block_cached__decode_kernel
  .amdhsa_next_free_vgpr 512
  .amdhsa_next_free_sgpr 102
  .amdhsa_accum_offset 256
  .amdhsa_group_segment_fixed_size 0
  .amdhsa_kernarg_size 104
  .amdhsa_user_sgpr_count 2
  .amdhsa_user_sgpr_kernarg_segment_ptr 1
  .amdhsa_system_sgpr_workgroup_id_x 1
.end_amdhsa_kernel
```
